```python
import torch

def _softmax(x, axis=-1):
    return torch.softmax(x, dim=axis)

def _gelu(x):
    return torch.nn.functional.gelu(x, approximate='tanh')

def _silu(x):
    return torch.nn.functional.silu(x)

def _sigmoid(x):
    return torch.sigmoid(x)

def _layernorm(x, axis=-1, eps=1e-05):
    m = x.mean(dim=axis, keepdim=True)
    v = x.var(dim=axis, keepdim=True, unbiased=False)
    return (x - m) / torch.sqrt(v + eps)

def _scatter_add(tgt, idx, src, axis=0):
    return tgt.clone().index_add_(axis, idx, src)

def _segment_sum(src, seg, n):
    out = torch.zeros((n,) + src.shape[1:], dtype=src.dtype)
    return out.index_add_(0, seg, src)

def _pad(x, pw):
    flat = tuple((v for pair in reversed(pw) for v in pair))
    return torch.nn.functional.pad(x, flat)
kernel_name = 'adaLN_cond__sliding_block_cached__geglu_ffn__decode'

def setup_inputs():

    _w = lambda a: (lambda t: t.to(torch.bfloat16) if t.is_floating_point() else t)(torch.as_tensor(a))

    def _A_setup():
        B, Sq, D = (2, 1, 512)
        Hq, Hkv, Sk, Dh = (32, 8, 32768, 128)
        assert Hq % Hkv == 0, (Hq, Hkv)
        return {'x': _w((lambda *s: torch.randn(*s, dtype=torch.bfloat16) * 0.05)(B, Sq, D)), 'k_cache': _w((lambda *s: torch.randn(*s, dtype=torch.bfloat16) * 3.2)(B, Hkv, Sk, Dh)), 'v_cache': _w((lambda *s: torch.randn(*s, dtype=torch.bfloat16) * 0.4)(B, Hkv, Sk, Dh)), 'wq': _w((lambda *s: torch.randn(*s, dtype=torch.bfloat16) * 3.2)(D, Hq * Dh) * D ** (-0.5)), 'wo': _w((lambda *s: torch.randn(*s, dtype=torch.bfloat16) * 0.4)(Hq * Dh, D) * (Hq * Dh) ** (-0.5))}
    _A_in = _A_setup()

    def _B_setup():
        B, S, D, F = (2, 1, 512, 1792)
        return {'x': _w((lambda *s: torch.randn(*s, dtype=torch.bfloat16) * 0.05)(B, S, D)), 'w_gate': _w((lambda *s: torch.randn(*s, dtype=torch.bfloat16) * 0.05)(D, F)), 'w_up': _w((lambda *s: torch.randn(*s, dtype=torch.bfloat16) * 0.05)(D, F)), 'w_down': _w((lambda *s: torch.randn(*s, dtype=torch.bfloat16) * 0.05)(F, D))}
    _B_in = _B_setup()
    return {'A_x': _A_in['x'], 'A_k_cache': _A_in['k_cache'], 'A_v_cache': _A_in['v_cache'], 'A_wq': _A_in['wq'], 'A_wo': _A_in['wo'], 'B_x': _B_in['x'], 'B_w_gate': _B_in['w_gate'], 'B_w_up': _B_in['w_up'], 'B_w_down': _B_in['w_down'], 'c': _w((lambda *s: torch.randn(*s, dtype=torch.bfloat16) * 0.2)(2, 512) * 8.0), 'w_mod': _w((lambda *s: torch.randn(*s, dtype=torch.bfloat16) * 0.2)(512, 6 * 512) * 512 ** (-0.5) * 8.0)}

def reference(A_x, A_k_cache, A_v_cache, A_wq, A_wo, B_x, B_w_gate, B_w_up, B_w_down, c, w_mod):

    def _A_ref(x, k_cache, v_cache, wq, wo):
        B, Sq, D = x.shape
        Hq, Dh = (32, 128)
        Hkv, Sk = (k_cache.shape[1], k_cache.shape[2])
        W = min(4096, max(256, Sk // 4))
        rep = Hq // Hkv
        q = (lambda x, *d: x.permute(*d))((x @ wq).reshape(B, Sq, Hq, Dh), 0, 2, 1, 3)
        k = (lambda x, n, axis: torch.repeat_interleave(x, n, dim=axis))(k_cache[:, :, Sk - W:, :], rep, axis=1)
        v = (lambda x, n, axis: torch.repeat_interleave(x, n, dim=axis))(v_cache[:, :, Sk - W:, :], rep, axis=1)
        scores = torch.einsum('bhqd,bhkd->bhqk', q, k) * Dh ** (-0.5)
        p = _softmax(scores, axis=-1)
        o = torch.einsum('bhqk,bhkd->bhqd', p, v)
        return (lambda x, *d: x.permute(*d))(o, 0, 2, 1, 3).reshape(B, Sq, Hq * Dh) @ wo

    def _B_ref(x, w_gate, w_up, w_down):
        return _gelu(x @ w_gate) * (x @ w_up) @ w_down
    x = A_x
    mod = (_silu(c) @ w_mod).reshape(c.shape[0], 6, 1, -1)
    sa, ca, ga, sb, cb, gb = (mod[:, 0].clone(), mod[:, 1].clone(), mod[:, 2].clone(), mod[:, 3].clone(), mod[:, 4].clone(), mod[:, 5].clone())
    h = _layernorm(x, axis=-1) * (1 + ca) + sa
    x = x + ga * _A_ref(h, A_k_cache, A_v_cache, A_wq, A_wo)
    h = _layernorm(x, axis=-1) * (1 + cb) + sb
    x = x + gb * _B_ref(h, B_w_gate, B_w_up, B_w_down)
    return x
```

```asm
; @launch grid=(256,1,1) block=(512,1,1) lds=144896
.amdgcn_target "amdgcn-amd-amdhsa--gfx950"
.text
.globl adaLN_cond__sliding_block_cached__geglu_ffn__decode_kernel
.p2align 8
.type adaLN_cond__sliding_block_cached__geglu_ffn__decode_kernel,@function
adaLN_cond__sliding_block_cached__geglu_ffn__decode_kernel:
    s_cmp_ge_u32 s2, 256
    s_cbranch_scc1 L_end
    v_cmp_lt_u32 vcc, 447, v0
    s_cbranch_vccz L_nocpf0
    s_getpc_b64 s[4:5]
L_pc0:
    s_sub_u32 s4, s4, L_pc0-adaLN_cond__sliding_block_cached__geglu_ffn__decode_kernel
    s_subb_u32 s5, s5, 0
    s_lshr_b32 s6, s2, 3
    s_lshl_b32 s6, s6, 10
    v_and_b32 v2, 63, v0
    v_lshlrev_b32 v2, 4, v2
    v_add_u32 v2, s6, v2
    v_min_u32 v2, L_code_end-adaLN_cond__sliding_block_cached__geglu_ffn__decode_kernel-16, v2
    global_load_dwordx4 v[8:11], v2, s[4:5]
L_nocpf0:
    s_load_dwordx16 s[16:31], s[0:1], 0
    s_load_dwordx8 s[32:39], s[0:1], 64
    s_load_dwordx4 s[40:43], s[0:1], 96
    v_lshrrev_b32 v1, 6, v0
    v_and_b32 v0, 63, v0
    s_and_b32 s66, s2, 7
    v_readfirstlane_b32 s44, v1
    s_bfe_u32 s67, s2, 0x40003
    s_mov_b32 s64, 0x05040100
    s_mov_b32 s65, 0x07060302
    s_mov_b32 s47, 2000000
    s_cmp_lt_u32 s2, 128
    s_cbranch_scc0 L_chain
L_attn:
    s_and_b32 s8, s67, 1
    s_lshr_b32 s9, s67, 1
    s_and_b32 s14, s44, 3
    s_lshl_b32 s3, s8, 3
    s_add_u32 s10, s66, 0
    s_and_b32 s10, s10, 7
    s_add_u32 s10, s10, s3
    s_lshl_b32 s3, s10, 23
    s_lshl_b32 s4, s9, 17
    s_lshl_b32 s5, s14, 15
    s_add_u32 s74, s3, s4
    s_add_u32 s74, s74, s5
    s_add_u32 s74, s74, 7340032
    s_mul_i32 s3, s9, 3
    s_mul_i32 s4, s10, 5
    s_add_u32 s3, s3, s4
    s_mul_i32 s4, s14, 11
    s_add_u32 s3, s3, s4
    s_and_b32 s3, s3, 31
    s_lshl_b32 s76, s3, 10
    s_cmp_ge_u32 s44, 4
    s_cbranch_scc1 L_attnV
    v_lshrrev_b32 v1, 4, v0
    v_and_b32 v2, 15, v0
    v_lshlrev_b32 v3, 2, v1
    v_xor_b32 v2, v2, v3
    v_lshlrev_b32 v1, 8, v1
    v_xor_b32 v3, 0, v2
    v_lshl_add_u32 v4, v3, 4, v1
    v_xor_b32 v3, 1, v2
    v_lshl_add_u32 v5, v3, 4, v1
    v_xor_b32 v3, 2, v2
    v_lshl_add_u32 v6, v3, 4, v1
    v_xor_b32 v3, 3, v2
    v_lshl_add_u32 v7, v3, 4, v1
    s_lshl_b32 s5, s14, 15
    s_mov_b32 m0, s5
    s_waitcnt lgkmcnt(0)
    s_load_dword s46, s[42:43], 0
    s_mov_b32 s52, s42
    s_mov_b32 s53, s43
    s_mov_b32 s54, 4194304
    s_mov_b32 s55, 0x00020000
    s_mov_b32 s48, s18
    s_mov_b32 s49, s19
    s_mov_b32 s50, 134217728
    s_mov_b32 s51, 0x00020000
    s_cmp_lt_u32 s66, 4
    s_cbranch_scc1 L_K_early
    s_mov_b32 s13, 0
L_K_loop:
    s_add_u32 s77, s74, s76
    buffer_load_dwordx4 v4, s[48:51], s77 offen nt lds
    s_add_u32 m0, m0, 1024
    s_add_u32 s76, s76, 1024
    s_and_b32 s76, s76, 0x7fff
    s_waitcnt vmcnt(8)
    s_add_u32 s77, s74, s76
    buffer_load_dwordx4 v5, s[48:51], s77 offen nt lds
    s_add_u32 m0, m0, 1024
    s_add_u32 s76, s76, 1024
    s_and_b32 s76, s76, 0x7fff
    s_waitcnt vmcnt(8)
    s_add_u32 s77, s74, s76
    buffer_load_dwordx4 v6, s[48:51], s77 offen nt lds
    s_add_u32 m0, m0, 1024
    s_add_u32 s76, s76, 1024
    s_and_b32 s76, s76, 0x7fff
    s_waitcnt vmcnt(8)
    s_add_u32 s77, s74, s76
    buffer_load_dwordx4 v7, s[48:51], s77 offen nt lds
    s_add_u32 m0, m0, 1024
    s_add_u32 s76, s76, 1024
    s_and_b32 s76, s76, 0x7fff
    s_waitcnt vmcnt(8)
    s_add_u32 s13, s13, 1
    s_cmp_eq_u32 s13, 2
    s_cbranch_scc0 L_K_nob0
    v_mov_b32 v56, 132352
    v_mov_b32 v57, 0
    ds_write_b32 v56, v57
    s_waitcnt lgkmcnt(0)
    s_barrier
L_K_nob0:
    s_cmp_lt_u32 s13, 8
    s_cbranch_scc1 L_K_loop
    s_branch L_K_issued
L_K_early:
    s_mov_b32 s13, 0
L_K_loope:
    s_add_u32 s77, s74, s76
    buffer_load_dwordx4 v4, s[48:51], s77 offen nt lds
    s_add_u32 m0, m0, 1024
    s_add_u32 s76, s76, 1024
    s_and_b32 s76, s76, 0x7fff
    s_waitcnt vmcnt(7)
    s_add_u32 s77, s74, s76
    buffer_load_dwordx4 v5, s[48:51], s77 offen nt lds
    s_add_u32 m0, m0, 1024
    s_add_u32 s76, s76, 1024
    s_and_b32 s76, s76, 0x7fff
    s_waitcnt vmcnt(7)
    s_add_u32 s77, s74, s76
    buffer_load_dwordx4 v6, s[48:51], s77 offen nt lds
    s_add_u32 m0, m0, 1024
    s_add_u32 s76, s76, 1024
    s_and_b32 s76, s76, 0x7fff
    s_waitcnt vmcnt(7)
    s_add_u32 s77, s74, s76
    buffer_load_dwordx4 v7, s[48:51], s77 offen nt lds
    s_add_u32 m0, m0, 1024
    s_add_u32 s76, s76, 1024
    s_and_b32 s76, s76, 0x7fff
    s_waitcnt vmcnt(7)
    s_add_u32 s13, s13, 1
    s_cmp_eq_u32 s13, 2
    s_cbranch_scc0 L_K_nob0e
    v_mov_b32 v56, 132352
    v_mov_b32 v57, 0
    ds_write_b32 v56, v57
    s_waitcnt lgkmcnt(0)
    s_barrier
L_K_nob0e:
    s_cmp_lt_u32 s13, 8
    s_cbranch_scc1 L_K_loope
L_K_issued:
    s_waitcnt lgkmcnt(0)
    s_add_u32 s45, s46, 1
    s_and_b32 s45, s45, 0xff
    v_and_b32 v1, 15, v0
    v_and_b32 v2, 3, v1
    v_lshrrev_b32 v3, 2, v1
    v_lshl_add_u32 v2, v2, 2, v3
    v_lshlrev_b32 v2, 8, v2
    s_lshl_b32 s5, s14, 15
    v_add_u32 v2, s5, v2
    v_lshrrev_b32 v3, 4, v0
    v_add_u32 v57, 0, v3
    v_xor_b32 v57, v57, v1
    v_lshl_add_u32 v4, v57, 4, v2
    v_add_u32 v57, 4, v3
    v_xor_b32 v57, v57, v1
    v_lshl_add_u32 v5, v57, 4, v2
    v_add_u32 v57, 8, v3
    v_xor_b32 v57, v57, v1
    v_lshl_add_u32 v6, v57, 4, v2
    v_add_u32 v57, 12, v3
    v_xor_b32 v57, v57, v1
    v_lshl_add_u32 v7, v57, 4, v2
    v_and_b32 v1, 3, v0
    v_mul_u32_u24 v1, 320, v1
    v_lshrrev_b32 v2, 4, v0
    v_lshl_add_u32 v57, v2, 4, v1
    v_add_u32 v57, 131072, v57
    s_mov_b32 s68, 0x00f000f0
    s_mov_b32 s69, 0x00f000f0
    s_mov_b32 s70, 0x0f000f00
    s_mov_b32 s71, 0x0f000f00
    s_mov_b32 s72, 0xf000f000
    s_mov_b32 s73, 0xf000f000
    s_cmp_lg_u32 s44, 0
    s_cbranch_scc1 L_A_kf
    s_lshl_b32 s5, s66, 1
    s_add_u32 s5, s5, s8
    s_lshl_b32 s5, s5, 13
    s_add_u32 s11, s5, 1179648
    s_add_u32 s12, s11, 4096
    s_mov_b32 s15, 40
    v_lshlrev_b32 v58, 4, v0
    s_waitcnt vmcnt(0)
    buffer_load_dwordx4 v[64:67], v58, s[52:55], s11 offen offset:0 sc1
    buffer_load_dwordx4 v[68:71], v58, s[52:55], s11 offen offset:1024 sc1
    buffer_load_dwordx4 v[72:75], v58, s[52:55], s11 offen offset:2048 sc1
    buffer_load_dwordx4 v[76:79], v58, s[52:55], s11 offen offset:3072 sc1
    buffer_load_dwordx4 v[80:83], v58, s[52:55], s12 offen offset:0 sc1
    buffer_load_dwordx4 v[84:87], v58, s[52:55], s12 offen offset:1024 sc1
    buffer_load_dwordx4 v[88:91], v58, s[52:55], s12 offen offset:2048 sc1
    buffer_load_dwordx4 v[92:95], v58, s[52:55], s12 offen offset:3072 sc1
    s_waitcnt vmcnt(8)
    ds_read_b128 v[128:131], v4 offset:0
    ds_read_b128 v[132:135], v5 offset:0
    ds_read_b128 v[136:139], v6 offset:0
    ds_read_b128 v[140:143], v7 offset:0
    ds_read_b128 v[144:147], v4 offset:4096
    ds_read_b128 v[148:151], v5 offset:4096
    ds_read_b128 v[152:155], v6 offset:4096
    ds_read_b128 v[156:159], v7 offset:4096
    s_waitcnt lgkmcnt(4)
    ds_read_b128 v[160:163], v4 offset:8192
    ds_read_b128 v[164:167], v5 offset:8192
    ds_read_b128 v[168:171], v6 offset:8192
    ds_read_b128 v[172:175], v7 offset:8192
    ds_read_b128 v[176:179], v4 offset:12288
    ds_read_b128 v[180:183], v5 offset:12288
    ds_read_b128 v[184:187], v6 offset:12288
    ds_read_b128 v[188:191], v7 offset:12288
    s_waitcnt lgkmcnt(4)
    ds_read_b128 v[192:195], v4 offset:16384
    ds_read_b128 v[196:199], v5 offset:16384
    ds_read_b128 v[200:203], v6 offset:16384
    ds_read_b128 v[204:207], v7 offset:16384
    ds_read_b128 v[208:211], v4 offset:20480
    ds_read_b128 v[212:215], v5 offset:20480
    ds_read_b128 v[216:219], v6 offset:20480
    ds_read_b128 v[220:223], v7 offset:20480
    s_waitcnt lgkmcnt(4)
    ds_read_b128 v[224:227], v4 offset:24576
    ds_read_b128 v[228:231], v5 offset:24576
    ds_read_b128 v[232:235], v6 offset:24576
    ds_read_b128 v[236:239], v7 offset:24576
    ds_read_b128 v[240:243], v4 offset:28672
    ds_read_b128 v[244:247], v5 offset:28672
    ds_read_b128 v[248:251], v6 offset:28672
    ds_read_b128 v[252:255], v7 offset:28672
    s_waitcnt lgkmcnt(4)
    s_branch L_A_h2_chk
L_A_h2:
    s_sub_u32 s15, s15, 1
    s_cmp_eq_u32 s15, 0
    s_cbranch_scc0 L_A_h2_go
    s_sub_u32 s11, s11, 1048576
    s_sub_u32 s12, s12, 1048576
L_A_h2_go:
    buffer_load_dwordx4 v[64:67], v58, s[52:55], s11 offen offset:0 sc1
    buffer_load_dwordx4 v[68:71], v58, s[52:55], s11 offen offset:1024 sc1
    buffer_load_dwordx4 v[72:75], v58, s[52:55], s11 offen offset:2048 sc1
    buffer_load_dwordx4 v[76:79], v58, s[52:55], s11 offen offset:3072 sc1
    buffer_load_dwordx4 v[80:83], v58, s[52:55], s12 offen offset:0 sc1
    buffer_load_dwordx4 v[84:87], v58, s[52:55], s12 offen offset:1024 sc1
    buffer_load_dwordx4 v[88:91], v58, s[52:55], s12 offen offset:2048 sc1
    buffer_load_dwordx4 v[92:95], v58, s[52:55], s12 offen offset:3072 sc1
L_A_h2_chk:
    s_waitcnt vmcnt(0)
    v_bitop3_b32 v96, v64, v65, s45 bitop3:0x7e
    v_bitop3_b32 v97, v66, v67, s45 bitop3:0x7e
    v_bitop3_b32 v98, v68, v69, s45 bitop3:0x7e
    v_bitop3_b32 v99, v70, v71, s45 bitop3:0x7e
    v_bitop3_b32 v100, v72, v73, s45 bitop3:0x7e
    v_bitop3_b32 v101, v74, v75, s45 bitop3:0x7e
    v_bitop3_b32 v102, v76, v77, s45 bitop3:0x7e
    v_bitop3_b32 v103, v78, v79, s45 bitop3:0x7e
    v_bitop3_b32 v104, v80, v81, s45 bitop3:0x7e
    v_bitop3_b32 v105, v82, v83, s45 bitop3:0x7e
    v_bitop3_b32 v106, v84, v85, s45 bitop3:0x7e
    v_bitop3_b32 v107, v86, v87, s45 bitop3:0x7e
    v_bitop3_b32 v108, v88, v89, s45 bitop3:0x7e
    v_bitop3_b32 v109, v90, v91, s45 bitop3:0x7e
    v_bitop3_b32 v110, v92, v93, s45 bitop3:0x7e
    v_bitop3_b32 v111, v94, v95, s45 bitop3:0x7e
    v_or3_b32 v96, v96, v97, v98
    v_or3_b32 v99, v99, v100, v101
    v_or3_b32 v102, v102, v103, v104
    v_or3_b32 v105, v105, v106, v107
    v_or3_b32 v108, v108, v109, v110
    v_or3_b32 v96, v96, v99, v102
    v_or3_b32 v105, v105, v108, v111
    v_or_b32 v96, v96, v105
    v_and_b32 v96, 0xff, v96
    v_cmp_ne_u32 vcc, 0, v96
    s_cbranch_vccz L_A_h2_ok
    s_sub_u32 s47, s47, 1
    s_cmp_gt_i32 s47, 0
    s_cbranch_scc1 L_A_h2
L_A_h2_ok:
    v_and_b32 v64, 0xffffff00, v64
    v_and_b32 v65, 0xffffff00, v65
    v_and_b32 v66, 0xffffff00, v66
    v_and_b32 v67, 0xffffff00, v67
    v_and_b32 v68, 0xffffff00, v68
    v_and_b32 v69, 0xffffff00, v69
    v_and_b32 v70, 0xffffff00, v70
    v_and_b32 v71, 0xffffff00, v71
    v_and_b32 v72, 0xffffff00, v72
    v_and_b32 v73, 0xffffff00, v73
    v_and_b32 v74, 0xffffff00, v74
    v_and_b32 v75, 0xffffff00, v75
    v_and_b32 v76, 0xffffff00, v76
    v_and_b32 v77, 0xffffff00, v77
    v_and_b32 v78, 0xffffff00, v78
    v_and_b32 v79, 0xffffff00, v79
    v_and_b32 v80, 0xffffff00, v80
    v_and_b32 v81, 0xffffff00, v81
    v_and_b32 v82, 0xffffff00, v82
    v_and_b32 v83, 0xffffff00, v83
    v_and_b32 v84, 0xffffff00, v84
    v_and_b32 v85, 0xffffff00, v85
    v_and_b32 v86, 0xffffff00, v86
    v_and_b32 v87, 0xffffff00, v87
    v_and_b32 v88, 0xffffff00, v88
    v_and_b32 v89, 0xffffff00, v89
    v_and_b32 v90, 0xffffff00, v90
    v_and_b32 v91, 0xffffff00, v91
    v_and_b32 v92, 0xffffff00, v92
    v_and_b32 v93, 0xffffff00, v93
    v_and_b32 v94, 0xffffff00, v94
    v_and_b32 v95, 0xffffff00, v95
    v_pk_add_f32 v[64:65], v[64:65], v[72:73]
    v_pk_add_f32 v[66:67], v[66:67], v[74:75]
    v_pk_add_f32 v[68:69], v[68:69], v[76:77]
    v_pk_add_f32 v[70:71], v[70:71], v[78:79]
    v_pk_add_f32 v[80:81], v[80:81], v[88:89]
    v_pk_add_f32 v[82:83], v[82:83], v[90:91]
    v_pk_add_f32 v[84:85], v[84:85], v[92:93]
    v_pk_add_f32 v[86:87], v[86:87], v[94:95]
    v_pk_add_f32 v[64:65], v[64:65], v[80:81]
    v_pk_add_f32 v[66:67], v[66:67], v[82:83]
    v_pk_add_f32 v[68:69], v[68:69], v[84:85]
    v_pk_add_f32 v[70:71], v[70:71], v[86:87]
    v_cvt_pk_bf16_f32 v8, v64, v65
    v_cvt_pk_bf16_f32 v9, v66, v67
    v_cvt_pk_bf16_f32 v10, v68, v69
    v_cvt_pk_bf16_f32 v11, v70, v71
    v_lshrrev_b32 v1, 5, v0
    v_mul_u32_u24 v1, 320, v1
    v_and_b32 v2, 31, v0
    v_lshl_add_u32 v1, v2, 3, v1
    v_add_u32 v1, 131072, v1
    ds_write_b64 v1, v[8:9]
    ds_write_b64 v1, v[10:11] offset:640
    v_mov_b32 v2, 1
    s_waitcnt lgkmcnt(0)
    ds_write_b32 v56, v2
    s_branch L_A_qready
L_A_kf:
    s_waitcnt vmcnt(0)
    ds_read_b128 v[128:131], v4 offset:0
    ds_read_b128 v[132:135], v5 offset:0
    ds_read_b128 v[136:139], v6 offset:0
    ds_read_b128 v[140:143], v7 offset:0
    ds_read_b128 v[144:147], v4 offset:4096
    ds_read_b128 v[148:151], v5 offset:4096
    ds_read_b128 v[152:155], v6 offset:4096
    ds_read_b128 v[156:159], v7 offset:4096
    s_waitcnt lgkmcnt(4)
    ds_read_b128 v[160:163], v4 offset:8192
    ds_read_b128 v[164:167], v5 offset:8192
    ds_read_b128 v[168:171], v6 offset:8192
    ds_read_b128 v[172:175], v7 offset:8192
    ds_read_b128 v[176:179], v4 offset:12288
    ds_read_b128 v[180:183], v5 offset:12288
    ds_read_b128 v[184:187], v6 offset:12288
    ds_read_b128 v[188:191], v7 offset:12288
    s_waitcnt lgkmcnt(4)
    ds_read_b128 v[192:195], v4 offset:16384
    ds_read_b128 v[196:199], v5 offset:16384
    ds_read_b128 v[200:203], v6 offset:16384
    ds_read_b128 v[204:207], v7 offset:16384
    ds_read_b128 v[208:211], v4 offset:20480
    ds_read_b128 v[212:215], v5 offset:20480
    ds_read_b128 v[216:219], v6 offset:20480
    ds_read_b128 v[220:223], v7 offset:20480
    s_waitcnt lgkmcnt(4)
    ds_read_b128 v[224:227], v4 offset:24576
    ds_read_b128 v[228:231], v5 offset:24576
    ds_read_b128 v[232:235], v6 offset:24576
    ds_read_b128 v[236:239], v7 offset:24576
    ds_read_b128 v[240:243], v4 offset:28672
    ds_read_b128 v[244:247], v5 offset:28672
    ds_read_b128 v[248:251], v6 offset:28672
    ds_read_b128 v[252:255], v7 offset:28672
    s_waitcnt lgkmcnt(4)
L_A_spin:
    ds_read_b32 v1, v56
    s_waitcnt lgkmcnt(0)
    v_readfirstlane_b32 s3, v1
    s_cmp_lg_u32 s3, 0
    s_cbranch_scc1 L_A_qready
    s_sleep 1
    s_sub_u32 s47, s47, 1
    s_cmp_gt_i32 s47, 0
    s_cbranch_scc1 L_A_spin
L_A_qready:
    ds_read_b128 v[8:11], v57 offset:0
    ds_read_b128 v[12:15], v57 offset:64
    ds_read_b128 v[16:19], v57 offset:128
    ds_read_b128 v[20:23], v57 offset:192
    v_bfe_u32 v1, v0, 3, 1
    v_lshlrev_b32 v1, 8, v1
    v_lshrrev_b32 v2, 4, v0
    v_lshl_add_u32 v1, v2, 6, v1
    v_and_b32 v2, 3, v0
    v_lshl_add_u32 v1, v2, 4, v1
    v_bfe_u32 v2, v0, 2, 1
    v_lshl_add_u32 v1, v2, 3, v1
    s_lshl_b32 s5, s14, 10
    s_add_u32 s5, s5, 132608
    v_add_u32 v1, s5, v1
    s_waitcnt lgkmcnt(3)
    v_mfma_f32_16x16x32_bf16 v[24:27], v[128:131], v[8:11], 0
    v_mfma_f32_16x16x32_bf16 v[28:31], v[144:147], v[8:11], 0
    v_mfma_f32_16x16x32_bf16 v[32:35], v[160:163], v[8:11], 0
    v_mfma_f32_16x16x32_bf16 v[36:39], v[176:179], v[8:11], 0
    v_mfma_f32_16x16x32_bf16 v[40:43], v[192:195], v[8:11], 0
    v_mfma_f32_16x16x32_bf16 v[44:47], v[208:211], v[8:11], 0
    v_mfma_f32_16x16x32_bf16 v[48:51], v[224:227], v[8:11], 0
    v_mfma_f32_16x16x32_bf16 v[52:55], v[240:243], v[8:11], 0
    s_waitcnt lgkmcnt(2)
    v_mfma_f32_16x16x32_bf16 v[24:27], v[132:135], v[12:15], v[24:27]
    v_mfma_f32_16x16x32_bf16 v[28:31], v[148:151], v[12:15], v[28:31]
    v_mfma_f32_16x16x32_bf16 v[32:35], v[164:167], v[12:15], v[32:35]
    v_mfma_f32_16x16x32_bf16 v[36:39], v[180:183], v[12:15], v[36:39]
    v_mfma_f32_16x16x32_bf16 v[40:43], v[196:199], v[12:15], v[40:43]
    v_mfma_f32_16x16x32_bf16 v[44:47], v[212:215], v[12:15], v[44:47]
    v_mfma_f32_16x16x32_bf16 v[48:51], v[228:231], v[12:15], v[48:51]
    v_mfma_f32_16x16x32_bf16 v[52:55], v[244:247], v[12:15], v[52:55]
    s_waitcnt lgkmcnt(1)
    v_mfma_f32_16x16x32_bf16 v[24:27], v[136:139], v[16:19], v[24:27]
    v_mfma_f32_16x16x32_bf16 v[28:31], v[152:155], v[16:19], v[28:31]
    v_mfma_f32_16x16x32_bf16 v[32:35], v[168:171], v[16:19], v[32:35]
    v_mfma_f32_16x16x32_bf16 v[36:39], v[184:187], v[16:19], v[36:39]
    v_mfma_f32_16x16x32_bf16 v[40:43], v[200:203], v[16:19], v[40:43]
    v_mfma_f32_16x16x32_bf16 v[44:47], v[216:219], v[16:19], v[44:47]
    v_mfma_f32_16x16x32_bf16 v[48:51], v[232:235], v[16:19], v[48:51]
    v_mfma_f32_16x16x32_bf16 v[52:55], v[248:251], v[16:19], v[52:55]
    s_waitcnt lgkmcnt(0)
    v_mfma_f32_16x16x32_bf16 v[24:27], v[140:143], v[20:23], v[24:27]
    v_mfma_f32_16x16x32_bf16 v[28:31], v[156:159], v[20:23], v[28:31]
    v_mfma_f32_16x16x32_bf16 v[32:35], v[172:175], v[20:23], v[32:35]
    v_mfma_f32_16x16x32_bf16 v[36:39], v[188:191], v[20:23], v[36:39]
    v_mfma_f32_16x16x32_bf16 v[40:43], v[204:207], v[20:23], v[40:43]
    v_mfma_f32_16x16x32_bf16 v[44:47], v[220:223], v[20:23], v[44:47]
    v_mfma_f32_16x16x32_bf16 v[48:51], v[236:239], v[20:23], v[48:51]
    v_mfma_f32_16x16x32_bf16 v[52:55], v[252:255], v[20:23], v[52:55]
    s_nop 1
    v_cndmask_b32 v64, v24, v28, s[68:69]
    v_cndmask_b32 v65, v25, v29, s[68:69]
    v_cndmask_b32 v66, v26, v30, s[68:69]
    v_cndmask_b32 v67, v27, v31, s[68:69]
    v_cndmask_b32 v64, v64, v32, s[70:71]
    v_cndmask_b32 v65, v65, v33, s[70:71]
    v_cndmask_b32 v66, v66, v34, s[70:71]
    v_cndmask_b32 v67, v67, v35, s[70:71]
    v_cndmask_b32 v64, v64, v36, s[72:73]
    v_cndmask_b32 v65, v65, v37, s[72:73]
    v_cndmask_b32 v66, v66, v38, s[72:73]
    v_cndmask_b32 v67, v67, v39, s[72:73]
    v_cndmask_b32 v68, v40, v44, s[68:69]
    v_cndmask_b32 v69, v41, v45, s[68:69]
    v_cndmask_b32 v70, v42, v46, s[68:69]
    v_cndmask_b32 v71, v43, v47, s[68:69]
    v_cndmask_b32 v68, v68, v48, s[70:71]
    v_cndmask_b32 v69, v69, v49, s[70:71]
    v_cndmask_b32 v70, v70, v50, s[70:71]
    v_cndmask_b32 v71, v71, v51, s[70:71]
    v_cndmask_b32 v68, v68, v52, s[72:73]
    v_cndmask_b32 v69, v69, v53, s[72:73]
    v_cndmask_b32 v70, v70, v54, s[72:73]
    v_cndmask_b32 v71, v71, v55, s[72:73]
    v_cvt_pk_bf16_f32 v76, v64, v65
    v_cvt_pk_bf16_f32 v77, v66, v67
    v_cvt_pk_bf16_f32 v78, v68, v69
    v_cvt_pk_bf16_f32 v79, v70, v71
    v_lshlrev_b32 v64, 16, v76
    v_and_b32 v65, 0xffff0000, v76
    v_lshlrev_b32 v66, 16, v77
    v_and_b32 v67, 0xffff0000, v77
    v_lshlrev_b32 v68, 16, v78
    v_and_b32 v69, 0xffff0000, v78
    v_lshlrev_b32 v70, 16, v79
    v_and_b32 v71, 0xffff0000, v79
    s_mov_b32 s3, 0x3db504f3
    v_mul_f32 v64, s3, v64
    v_mul_f32 v65, s3, v65
    v_mul_f32 v66, s3, v66
    v_mul_f32 v67, s3, v67
    v_mul_f32 v68, s3, v68
    v_mul_f32 v69, s3, v69
    v_mul_f32 v70, s3, v70
    v_mul_f32 v71, s3, v71
    v_cvt_pk_bf16_f32 v76, v64, v65
    v_cvt_pk_bf16_f32 v77, v66, v67
    v_cvt_pk_bf16_f32 v78, v68, v69
    v_cvt_pk_bf16_f32 v79, v70, v71
    v_lshlrev_b32 v64, 16, v76
    v_and_b32 v65, 0xffff0000, v76
    v_lshlrev_b32 v66, 16, v77
    v_and_b32 v67, 0xffff0000, v77
    v_lshlrev_b32 v68, 16, v78
    v_and_b32 v69, 0xffff0000, v78
    v_lshlrev_b32 v70, 16, v79
    v_and_b32 v71, 0xffff0000, v79
    v_max3_f32 v80, v64, v65, v66
    v_max3_f32 v81, v67, v68, v69
    v_max3_f32 v80, v80, v70, v71
    v_max_f32 v80, v80, v81
    s_nop 1
    v_max_f32_dpp v80, v80, v80 row_ror:4 row_mask:0xf bank_mask:0xf
    s_nop 1
    v_max_f32_dpp v80, v80, v80 row_ror:8 row_mask:0xf bank_mask:0xf
    v_mov_b32 v81, v80
    s_nop 1
    v_permlane16_swap_b32 v80, v81
    v_max_f32 v80, v80, v81
    v_mov_b32 v81, v80
    s_nop 1
    v_permlane32_swap_b32 v80, v81
    v_max_f32 v80, v80, v81
    s_mov_b32 s3, 0x3fb8aa3b
    v_mul_f32 v81, s3, v80
    v_fma_f32 v64, v64, s3, -v81
    v_fma_f32 v65, v65, s3, -v81
    v_fma_f32 v66, v66, s3, -v81
    v_fma_f32 v67, v67, s3, -v81
    v_fma_f32 v68, v68, s3, -v81
    v_fma_f32 v69, v69, s3, -v81
    v_fma_f32 v70, v70, s3, -v81
    v_fma_f32 v71, v71, s3, -v81
    v_exp_f32 v64, v64
    v_exp_f32 v65, v65
    v_exp_f32 v66, v66
    v_exp_f32 v67, v67
    v_exp_f32 v68, v68
    v_exp_f32 v69, v69
    v_exp_f32 v70, v70
    v_exp_f32 v71, v71
    v_cvt_pk_bf16_f32 v82, v64, v65
    v_cvt_pk_bf16_f32 v83, v66, v67
    v_cvt_pk_bf16_f32 v84, v68, v69
    v_cvt_pk_bf16_f32 v85, v70, v71
    v_and_b32 v2, 3, v0
    v_lshlrev_b32 v2, 2, v2
    s_lshl_b32 s5, s14, 4
    s_add_u32 s5, s5, 132416
    v_add_u32 v3, s5, v2
    ds_write_b64 v1, v[82:83]
    ds_write_b64 v1, v[84:85] offset:512
    s_mov_b32 exec_lo, 0x0000000f
    s_mov_b32 exec_hi, 0
    ds_write_b32 v3, v80
    s_mov_b64 exec, -1
    s_waitcnt lgkmcnt(0)
    s_barrier
    v_add_u32 v3, 132416, v2
    ds_read_b32 v8, v3
    ds_read_b32 v9, v3 offset:16
    ds_read_b32 v10, v3 offset:32
    ds_read_b32 v11, v3 offset:48
    s_waitcnt lgkmcnt(0)
    v_max3_f32 v12, v8, v9, v10
    v_max_f32 v12, v12, v11
    v_sub_f32 v13, v80, v12
    v_mul_f32 v13, 0x3fb8aa3b, v13
    v_exp_f32 v13, v13
    s_lshl_b32 s5, s14, 4
    s_add_u32 s5, s5, 132480
    v_add_u32 v3, s5, v2
    s_mov_b32 exec_lo, 0x0000000f
    s_mov_b32 exec_hi, 0
    ds_write_b32 v3, v13
    s_mov_b64 exec, -1
    v_mov_b32 v59, 0xffffff00
    v_lshlrev_b32 v1, 4, v0
    s_lshl_b32 s5, s44, 10
    s_add_u32 s5, s5, 136704
    v_add_u32 v2, s5, v1
    s_lshl_b32 s3, s66, 15
    s_lshl_b32 s4, s44, 14
    s_add_u32 s3, s3, s4
    s_lshl_b32 s4, s8, 12
    s_add_u32 s3, s3, s4
    s_lshl_b32 s4, s9, 9
    s_add_u32 s3, s3, s4
    s_add_u32 s13, s3, 524288
    v_lshrrev_b32 v3, 5, v0
    v_lshlrev_b32 v4, 13, v3
    v_and_b32 v5, 31, v0
    v_lshl_add_u32 v4, v5, 4, v4
    s_lshl_b32 s5, s44, 3
    s_add_u32 s5, s5, 132480
    v_lshlrev_b32 v3, 2, v3
    v_add_u32 v3, s5, v3
    s_waitcnt lgkmcnt(0)
    s_barrier
    s_cmp_eq_u32 s44, 2
    s_cbranch_scc1 L_A_ml
    s_cmp_gt_u32 s44, 2
    s_cbranch_scc1 L_A_done
    ds_read_b128 v[8:11], v2 offset:0
    ds_read_b128 v[12:15], v2 offset:2048
    ds_read_b128 v[16:19], v2 offset:4096
    ds_read_b128 v[20:23], v2 offset:6144
    ds_read_b32 v24, v3 offset:0
    ds_read_b32 v25, v3 offset:16
    ds_read_b32 v26, v3 offset:32
    ds_read_b32 v27, v3 offset:48
    s_waitcnt lgkmcnt(0)
    v_mul_f32 v8, v24, v8
    v_mul_f32 v9, v24, v9
    v_mul_f32 v10, v24, v10
    v_mul_f32 v11, v24, v11
    v_fmac_f32 v8, v25, v12
    v_fmac_f32 v9, v25, v13
    v_fmac_f32 v10, v25, v14
    v_fmac_f32 v11, v25, v15
    v_fmac_f32 v8, v26, v16
    v_fmac_f32 v9, v26, v17
    v_fmac_f32 v10, v26, v18
    v_fmac_f32 v11, v26, v19
    v_fmac_f32 v8, v27, v20
    v_fmac_f32 v9, v27, v21
    v_fmac_f32 v10, v27, v22
    v_fmac_f32 v11, v27, v23
    v_bfi_b32 v8, v59, v8, s45
    v_bfi_b32 v9, v59, v9, s45
    v_bfi_b32 v10, v59, v10, s45
    v_bfi_b32 v11, v59, v11, s45
    s_add_u32 s12, s13, 1048576
    buffer_store_dwordx4 v[8:11], v4, s[52:55], s12 offen
    buffer_store_dwordx4 v[8:11], v4, s[52:55], s13 offen sc1
    s_branch L_A_done
L_A_ml:
    v_and_b32 v1, 3, v0
    v_lshlrev_b32 v2, 2, v1
    v_add_u32 v6, 132544, v2
    v_add_u32 v7, 132480, v2
    ds_read_b32 v8, v6 offset:0
    ds_read_b32 v24, v7 offset:0
    ds_read_b32 v9, v6 offset:16
    ds_read_b32 v25, v7 offset:16
    ds_read_b32 v10, v6 offset:32
    ds_read_b32 v26, v7 offset:32
    ds_read_b32 v11, v6 offset:48
    ds_read_b32 v27, v7 offset:48
    s_lshl_b32 s3, s66, 1
    s_add_u32 s3, s3, s8
    s_lshl_b32 s3, s3, 3
    s_add_u32 s3, s3, s9
    s_lshl_b32 s3, s3, 7
    s_add_u32 s3, s3, 262144
    v_lshlrev_b32 v3, 4, v1
    v_cmp_gt_u32 vcc, 4, v0
    v_mov_b32 v4, 1073741824
    s_add_u32 s4, s46, 1
    v_mov_b32 v22, s4
    v_mov_b32 v23, s4
    v_mov_b32 v20, v12
    v_cndmask_b32 v3, v4, v3, vcc
    s_waitcnt lgkmcnt(0)
    v_mul_f32 v21, v24, v8
    v_fmac_f32 v21, v25, v9
    v_fmac_f32 v21, v26, v10
    v_fmac_f32 v21, v27, v11
    v_bfi_b32 v20, v59, v20, s45
    v_bfi_b32 v21, v59, v21, s45
    s_add_u32 s12, s3, 1048576
    buffer_store_dwordx4 v[20:23], v3, s[52:55], s12 offen
    buffer_store_dwordx4 v[20:23], v3, s[52:55], s3 offen sc1
L_A_done:
    s_endpgm
L_attnV:
    v_lshlrev_b32 v56, 4, v0
    s_waitcnt lgkmcnt(0)
    s_load_dword s46, s[42:43], 0
    s_mov_b32 s52, s42
    s_mov_b32 s53, s43
    s_mov_b32 s54, 4194304
    s_mov_b32 s55, 0x00020000
    s_mov_b32 s56, s20
    s_mov_b32 s57, s21
    s_mov_b32 s58, 134217728
    s_mov_b32 s59, 0x00020000
    s_setprio 2
    s_cmp_lt_u32 s66, 4
    s_cbranch_scc1 L_V_early
    s_add_u32 s77, s74, s76
    buffer_load_dwordx4 v[64:67], v56, s[56:59], s77 offen nt
    s_add_u32 s76, s76, 1024
    s_and_b32 s76, s76, 0x7fff
    s_add_u32 s77, s74, s76
    buffer_load_dwordx4 v[68:71], v56, s[56:59], s77 offen nt
    s_add_u32 s76, s76, 1024
    s_and_b32 s76, s76, 0x7fff
    s_waitcnt vmcnt(1)
    s_waitcnt lgkmcnt(0)
    s_add_u32 s45, s46, 1
    s_and_b32 s45, s45, 0xff
    s_barrier
    s_add_u32 s77, s74, s76
    buffer_load_dwordx4 v[72:75], v56, s[56:59], s77 offen nt
    s_add_u32 s76, s76, 1024
    s_and_b32 s76, s76, 0x7fff
    s_waitcnt vmcnt(1)
    s_add_u32 s77, s74, s76
    buffer_load_dwordx4 v[76:79], v56, s[56:59], s77 offen nt
    s_add_u32 s76, s76, 1024
    s_and_b32 s76, s76, 0x7fff
    v_perm_b32 v192, v68, v64, s64
    v_perm_b32 v196, v68, v64, s65
    v_perm_b32 v200, v69, v65, s64
    v_perm_b32 v204, v69, v65, s65
    v_perm_b32 v208, v70, v66, s64
    v_perm_b32 v212, v70, v66, s65
    v_perm_b32 v216, v71, v67, s64
    v_perm_b32 v220, v71, v67, s65
    s_waitcnt vmcnt(1)
    s_add_u32 s77, s74, s76
    buffer_load_dwordx4 v[80:83], v56, s[56:59], s77 offen nt
    s_add_u32 s76, s76, 1024
    s_and_b32 s76, s76, 0x7fff
    s_waitcnt vmcnt(1)
    s_add_u32 s77, s74, s76
    buffer_load_dwordx4 v[84:87], v56, s[56:59], s77 offen nt
    s_add_u32 s76, s76, 1024
    s_and_b32 s76, s76, 0x7fff
    v_perm_b32 v193, v76, v72, s64
    v_perm_b32 v197, v76, v72, s65
    v_perm_b32 v201, v77, v73, s64
    v_perm_b32 v205, v77, v73, s65
    v_perm_b32 v209, v78, v74, s64
    v_perm_b32 v213, v78, v74, s65
    v_perm_b32 v217, v79, v75, s64
    v_perm_b32 v221, v79, v75, s65
    s_waitcnt vmcnt(1)
    s_add_u32 s77, s74, s76
    buffer_load_dwordx4 v[88:91], v56, s[56:59], s77 offen nt
    s_add_u32 s76, s76, 1024
    s_and_b32 s76, s76, 0x7fff
    s_waitcnt vmcnt(1)
    s_add_u32 s77, s74, s76
    buffer_load_dwordx4 v[92:95], v56, s[56:59], s77 offen nt
    s_add_u32 s76, s76, 1024
    s_and_b32 s76, s76, 0x7fff
    v_perm_b32 v194, v84, v80, s64
    v_perm_b32 v198, v84, v80, s65
    v_perm_b32 v202, v85, v81, s64
    v_perm_b32 v206, v85, v81, s65
    v_perm_b32 v210, v86, v82, s64
    v_perm_b32 v214, v86, v82, s65
    v_perm_b32 v218, v87, v83, s64
    v_perm_b32 v222, v87, v83, s65
    s_waitcnt vmcnt(1)
    s_add_u32 s77, s74, s76
    buffer_load_dwordx4 v[96:99], v56, s[56:59], s77 offen nt
    s_add_u32 s76, s76, 1024
    s_and_b32 s76, s76, 0x7fff
    s_waitcnt vmcnt(8)
    s_add_u32 s77, s74, s76
    buffer_load_dwordx4 v[100:103], v56, s[56:59], s77 offen nt
    s_add_u32 s76, s76, 1024
    s_and_b32 s76, s76, 0x7fff
    s_waitcnt vmcnt(8)
    s_add_u32 s77, s74, s76
    buffer_load_dwordx4 v[104:107], v56, s[56:59], s77 offen nt
    s_add_u32 s76, s76, 1024
    s_and_b32 s76, s76, 0x7fff
    s_waitcnt vmcnt(8)
    s_add_u32 s77, s74, s76
    buffer_load_dwordx4 v[108:111], v56, s[56:59], s77 offen nt
    s_add_u32 s76, s76, 1024
    s_and_b32 s76, s76, 0x7fff
    s_waitcnt vmcnt(8)
    s_add_u32 s77, s74, s76
    buffer_load_dwordx4 v[112:115], v56, s[56:59], s77 offen nt
    s_add_u32 s76, s76, 1024
    s_and_b32 s76, s76, 0x7fff
    s_waitcnt vmcnt(8)
    s_add_u32 s77, s74, s76
    buffer_load_dwordx4 v[116:119], v56, s[56:59], s77 offen nt
    s_add_u32 s76, s76, 1024
    s_and_b32 s76, s76, 0x7fff
    s_waitcnt vmcnt(8)
    s_add_u32 s77, s74, s76
    buffer_load_dwordx4 v[120:123], v56, s[56:59], s77 offen nt
    s_add_u32 s76, s76, 1024
    s_and_b32 s76, s76, 0x7fff
    s_waitcnt vmcnt(8)
    s_cmp_lg_u32 s44, 4
    s_cbranch_scc1 L_V_nohint1
    s_lshl_b32 s3, s2, 7
    s_add_u32 s3, s3, 344064
    s_add_u32 s4, s46, 1
    v_mov_b32 v57, s4
    v_cmp_eq_u32 vcc, 0, v0
    v_mov_b32 v58, 1073741824
    v_mov_b32 v59, 0
    v_cndmask_b32 v58, v58, v59, vcc
    buffer_store_dword v57, v58, s[52:55], s3 offen sc1
L_V_nohint1:
    s_add_u32 s77, s74, s76
    buffer_load_dwordx4 v[124:127], v56, s[56:59], s77 offen nt
    s_add_u32 s76, s76, 1024
    s_and_b32 s76, s76, 0x7fff
    s_waitcnt vmcnt(8)
    s_add_u32 s77, s74, s76
    buffer_load_dwordx4 v[128:131], v56, s[56:59], s77 offen nt
    s_add_u32 s76, s76, 1024
    s_and_b32 s76, s76, 0x7fff
    v_perm_b32 v195, v92, v88, s64
    v_perm_b32 v199, v92, v88, s65
    v_perm_b32 v203, v93, v89, s64
    v_perm_b32 v207, v93, v89, s65
    v_perm_b32 v211, v94, v90, s64
    v_perm_b32 v215, v94, v90, s65
    v_perm_b32 v219, v95, v91, s64
    v_perm_b32 v223, v95, v91, s65
    s_waitcnt vmcnt(8)
    s_add_u32 s77, s74, s76
    buffer_load_dwordx4 v[132:135], v56, s[56:59], s77 offen nt
    s_add_u32 s76, s76, 1024
    s_and_b32 s76, s76, 0x7fff
    s_waitcnt vmcnt(8)
    s_add_u32 s77, s74, s76
    buffer_load_dwordx4 v[136:139], v56, s[56:59], s77 offen nt
    s_add_u32 s76, s76, 1024
    s_and_b32 s76, s76, 0x7fff
    v_perm_b32 v64, v100, v96, s64
    v_perm_b32 v68, v100, v96, s65
    v_perm_b32 v72, v101, v97, s64
    v_perm_b32 v76, v101, v97, s65
    v_perm_b32 v80, v102, v98, s64
    v_perm_b32 v84, v102, v98, s65
    v_perm_b32 v88, v103, v99, s64
    v_perm_b32 v92, v103, v99, s65
    s_waitcnt vmcnt(8)
    s_add_u32 s77, s74, s76
    buffer_load_dwordx4 v[140:143], v56, s[56:59], s77 offen nt
    s_add_u32 s76, s76, 1024
    s_and_b32 s76, s76, 0x7fff
    s_waitcnt vmcnt(8)
    s_add_u32 s77, s74, s76
    buffer_load_dwordx4 v[144:147], v56, s[56:59], s77 offen nt
    s_add_u32 s76, s76, 1024
    s_and_b32 s76, s76, 0x7fff
    v_perm_b32 v65, v108, v104, s64
    v_perm_b32 v69, v108, v104, s65
    v_perm_b32 v73, v109, v105, s64
    v_perm_b32 v77, v109, v105, s65
    v_perm_b32 v81, v110, v106, s64
    v_perm_b32 v85, v110, v106, s65
    v_perm_b32 v89, v111, v107, s64
    v_perm_b32 v93, v111, v107, s65
    s_waitcnt vmcnt(8)
    s_add_u32 s77, s74, s76
    buffer_load_dwordx4 v[148:151], v56, s[56:59], s77 offen nt
    s_add_u32 s76, s76, 1024
    s_and_b32 s76, s76, 0x7fff
    s_waitcnt vmcnt(8)
    s_add_u32 s77, s74, s76
    buffer_load_dwordx4 v[152:155], v56, s[56:59], s77 offen nt
    s_add_u32 s76, s76, 1024
    s_and_b32 s76, s76, 0x7fff
    v_perm_b32 v66, v116, v112, s64
    v_perm_b32 v70, v116, v112, s65
    v_perm_b32 v74, v117, v113, s64
    v_perm_b32 v78, v117, v113, s65
    v_perm_b32 v82, v118, v114, s64
    v_perm_b32 v86, v118, v114, s65
    v_perm_b32 v90, v119, v115, s64
    v_perm_b32 v94, v119, v115, s65
    s_waitcnt vmcnt(8)
    s_cmp_lg_u32 s44, 4
    s_cbranch_scc1 L_V_nohint0
    s_lshl_b32 s3, s2, 7
    s_add_u32 s3, s3, 327680
    s_add_u32 s4, s46, 1
    v_mov_b32 v57, s4
    v_cmp_eq_u32 vcc, 0, v0
    v_mov_b32 v58, 1073741824
    v_mov_b32 v59, 0
    v_cndmask_b32 v58, v58, v59, vcc
    buffer_store_dword v57, v58, s[52:55], s3 offen sc1
L_V_nohint0:
    s_add_u32 s77, s74, s76
    buffer_load_dwordx4 v[156:159], v56, s[56:59], s77 offen nt
    s_add_u32 s76, s76, 1024
    s_and_b32 s76, s76, 0x7fff
    s_waitcnt vmcnt(8)
    s_add_u32 s77, s74, s76
    buffer_load_dwordx4 v[160:163], v56, s[56:59], s77 offen nt
    s_add_u32 s76, s76, 1024
    s_and_b32 s76, s76, 0x7fff
    v_perm_b32 v67, v124, v120, s64
    v_perm_b32 v71, v124, v120, s65
    v_perm_b32 v75, v125, v121, s64
    v_perm_b32 v79, v125, v121, s65
    v_perm_b32 v83, v126, v122, s64
    v_perm_b32 v87, v126, v122, s65
    v_perm_b32 v91, v127, v123, s64
    v_perm_b32 v95, v127, v123, s65
    s_waitcnt vmcnt(8)
    s_add_u32 s77, s74, s76
    buffer_load_dwordx4 v[164:167], v56, s[56:59], s77 offen nt
    s_add_u32 s76, s76, 1024
    s_and_b32 s76, s76, 0x7fff
    s_waitcnt vmcnt(8)
    s_add_u32 s77, s74, s76
    buffer_load_dwordx4 v[168:171], v56, s[56:59], s77 offen nt
    s_add_u32 s76, s76, 1024
    s_and_b32 s76, s76, 0x7fff
    v_perm_b32 v96, v132, v128, s64
    v_perm_b32 v100, v132, v128, s65
    v_perm_b32 v104, v133, v129, s64
    v_perm_b32 v108, v133, v129, s65
    v_perm_b32 v112, v134, v130, s64
    v_perm_b32 v116, v134, v130, s65
    v_perm_b32 v120, v135, v131, s64
    v_perm_b32 v124, v135, v131, s65
    s_waitcnt vmcnt(8)
    s_add_u32 s77, s74, s76
    buffer_load_dwordx4 v[172:175], v56, s[56:59], s77 offen nt
    s_add_u32 s76, s76, 1024
    s_and_b32 s76, s76, 0x7fff
    s_waitcnt vmcnt(8)
    s_add_u32 s77, s74, s76
    buffer_load_dwordx4 v[176:179], v56, s[56:59], s77 offen nt
    s_add_u32 s76, s76, 1024
    s_and_b32 s76, s76, 0x7fff
    v_perm_b32 v97, v140, v136, s64
    v_perm_b32 v101, v140, v136, s65
    v_perm_b32 v105, v141, v137, s64
    v_perm_b32 v109, v141, v137, s65
    v_perm_b32 v113, v142, v138, s64
    v_perm_b32 v117, v142, v138, s65
    v_perm_b32 v121, v143, v139, s64
    v_perm_b32 v125, v143, v139, s65
    s_waitcnt vmcnt(8)
    s_add_u32 s77, s74, s76
    buffer_load_dwordx4 v[180:183], v56, s[56:59], s77 offen nt
    s_add_u32 s76, s76, 1024
    s_and_b32 s76, s76, 0x7fff
    s_waitcnt vmcnt(8)
    s_add_u32 s77, s74, s76
    buffer_load_dwordx4 v[184:187], v56, s[56:59], s77 offen nt
    s_add_u32 s76, s76, 1024
    s_and_b32 s76, s76, 0x7fff
    v_perm_b32 v98, v148, v144, s64
    v_perm_b32 v102, v148, v144, s65
    v_perm_b32 v106, v149, v145, s64
    v_perm_b32 v110, v149, v145, s65
    v_perm_b32 v114, v150, v146, s64
    v_perm_b32 v118, v150, v146, s65
    v_perm_b32 v122, v151, v147, s64
    v_perm_b32 v126, v151, v147, s65
    s_waitcnt vmcnt(8)
    s_add_u32 s77, s74, s76
    buffer_load_dwordx4 v[188:191], v56, s[56:59], s77 offen nt
    s_add_u32 s76, s76, 1024
    s_and_b32 s76, s76, 0x7fff
    s_waitcnt vmcnt(8)
    v_perm_b32 v99, v156, v152, s64
    v_perm_b32 v103, v156, v152, s65
    v_perm_b32 v107, v157, v153, s64
    v_perm_b32 v111, v157, v153, s65
    v_perm_b32 v115, v158, v154, s64
    v_perm_b32 v119, v158, v154, s65
    v_perm_b32 v123, v159, v155, s64
    v_perm_b32 v127, v159, v155, s65
    s_branch L_V_issued
L_V_early:
    s_add_u32 s77, s74, s76
    buffer_load_dwordx4 v[64:67], v56, s[56:59], s77 offen nt
    s_add_u32 s76, s76, 1024
    s_and_b32 s76, s76, 0x7fff
    s_add_u32 s77, s74, s76
    buffer_load_dwordx4 v[68:71], v56, s[56:59], s77 offen nt
    s_add_u32 s76, s76, 1024
    s_and_b32 s76, s76, 0x7fff
    s_waitcnt vmcnt(1)
    s_waitcnt lgkmcnt(0)
    s_add_u32 s45, s46, 1
    s_and_b32 s45, s45, 0xff
    s_barrier
    s_add_u32 s77, s74, s76
    buffer_load_dwordx4 v[72:75], v56, s[56:59], s77 offen nt
    s_add_u32 s76, s76, 1024
    s_and_b32 s76, s76, 0x7fff
    s_waitcnt vmcnt(1)
    s_add_u32 s77, s74, s76
    buffer_load_dwordx4 v[76:79], v56, s[56:59], s77 offen nt
    s_add_u32 s76, s76, 1024
    s_and_b32 s76, s76, 0x7fff
    v_perm_b32 v192, v68, v64, s64
    v_perm_b32 v196, v68, v64, s65
    v_perm_b32 v200, v69, v65, s64
    v_perm_b32 v204, v69, v65, s65
    v_perm_b32 v208, v70, v66, s64
    v_perm_b32 v212, v70, v66, s65
    v_perm_b32 v216, v71, v67, s64
    v_perm_b32 v220, v71, v67, s65
    s_waitcnt vmcnt(1)
    s_add_u32 s77, s74, s76
    buffer_load_dwordx4 v[80:83], v56, s[56:59], s77 offen nt
    s_add_u32 s76, s76, 1024
    s_and_b32 s76, s76, 0x7fff
    s_waitcnt vmcnt(1)
    s_add_u32 s77, s74, s76
    buffer_load_dwordx4 v[84:87], v56, s[56:59], s77 offen nt
    s_add_u32 s76, s76, 1024
    s_and_b32 s76, s76, 0x7fff
    v_perm_b32 v193, v76, v72, s64
    v_perm_b32 v197, v76, v72, s65
    v_perm_b32 v201, v77, v73, s64
    v_perm_b32 v205, v77, v73, s65
    v_perm_b32 v209, v78, v74, s64
    v_perm_b32 v213, v78, v74, s65
    v_perm_b32 v217, v79, v75, s64
    v_perm_b32 v221, v79, v75, s65
    s_waitcnt vmcnt(1)
    s_add_u32 s77, s74, s76
    buffer_load_dwordx4 v[88:91], v56, s[56:59], s77 offen nt
    s_add_u32 s76, s76, 1024
    s_and_b32 s76, s76, 0x7fff
    s_waitcnt vmcnt(1)
    s_add_u32 s77, s74, s76
    buffer_load_dwordx4 v[92:95], v56, s[56:59], s77 offen nt
    s_add_u32 s76, s76, 1024
    s_and_b32 s76, s76, 0x7fff
    v_perm_b32 v194, v84, v80, s64
    v_perm_b32 v198, v84, v80, s65
    v_perm_b32 v202, v85, v81, s64
    v_perm_b32 v206, v85, v81, s65
    v_perm_b32 v210, v86, v82, s64
    v_perm_b32 v214, v86, v82, s65
    v_perm_b32 v218, v87, v83, s64
    v_perm_b32 v222, v87, v83, s65
    s_waitcnt vmcnt(1)
    s_add_u32 s77, s74, s76
    buffer_load_dwordx4 v[96:99], v56, s[56:59], s77 offen nt
    s_add_u32 s76, s76, 1024
    s_and_b32 s76, s76, 0x7fff
    s_waitcnt vmcnt(7)
    s_add_u32 s77, s74, s76
    buffer_load_dwordx4 v[100:103], v56, s[56:59], s77 offen nt
    s_add_u32 s76, s76, 1024
    s_and_b32 s76, s76, 0x7fff
    s_waitcnt vmcnt(7)
    s_add_u32 s77, s74, s76
    buffer_load_dwordx4 v[104:107], v56, s[56:59], s77 offen nt
    s_add_u32 s76, s76, 1024
    s_and_b32 s76, s76, 0x7fff
    s_waitcnt vmcnt(7)
    s_add_u32 s77, s74, s76
    buffer_load_dwordx4 v[108:111], v56, s[56:59], s77 offen nt
    s_add_u32 s76, s76, 1024
    s_and_b32 s76, s76, 0x7fff
    s_waitcnt vmcnt(7)
    s_add_u32 s77, s74, s76
    buffer_load_dwordx4 v[112:115], v56, s[56:59], s77 offen nt
    s_add_u32 s76, s76, 1024
    s_and_b32 s76, s76, 0x7fff
    s_waitcnt vmcnt(7)
    s_add_u32 s77, s74, s76
    buffer_load_dwordx4 v[116:119], v56, s[56:59], s77 offen nt
    s_add_u32 s76, s76, 1024
    s_and_b32 s76, s76, 0x7fff
    s_waitcnt vmcnt(7)
    s_add_u32 s77, s74, s76
    buffer_load_dwordx4 v[120:123], v56, s[56:59], s77 offen nt
    s_add_u32 s76, s76, 1024
    s_and_b32 s76, s76, 0x7fff
    s_waitcnt vmcnt(7)
    s_cmp_lg_u32 s44, 4
    s_cbranch_scc1 L_V_nohinte1
    s_lshl_b32 s3, s2, 7
    s_add_u32 s3, s3, 344064
    s_add_u32 s4, s46, 1
    v_mov_b32 v57, s4
    v_cmp_eq_u32 vcc, 0, v0
    v_mov_b32 v58, 1073741824
    v_mov_b32 v59, 0
    v_cndmask_b32 v58, v58, v59, vcc
    buffer_store_dword v57, v58, s[52:55], s3 offen sc1
L_V_nohinte1:
    s_add_u32 s77, s74, s76
    buffer_load_dwordx4 v[124:127], v56, s[56:59], s77 offen nt
    s_add_u32 s76, s76, 1024
    s_and_b32 s76, s76, 0x7fff
    v_perm_b32 v195, v92, v88, s64
    v_perm_b32 v199, v92, v88, s65
    v_perm_b32 v203, v93, v89, s64
    v_perm_b32 v207, v93, v89, s65
    v_perm_b32 v211, v94, v90, s64
    v_perm_b32 v215, v94, v90, s65
    v_perm_b32 v219, v95, v91, s64
    v_perm_b32 v223, v95, v91, s65
    s_waitcnt vmcnt(7)
    s_add_u32 s77, s74, s76
    buffer_load_dwordx4 v[128:131], v56, s[56:59], s77 offen nt
    s_add_u32 s76, s76, 1024
    s_and_b32 s76, s76, 0x7fff
    s_waitcnt vmcnt(7)
    s_add_u32 s77, s74, s76
    buffer_load_dwordx4 v[132:135], v56, s[56:59], s77 offen nt
    s_add_u32 s76, s76, 1024
    s_and_b32 s76, s76, 0x7fff
    v_perm_b32 v64, v100, v96, s64
    v_perm_b32 v68, v100, v96, s65
    v_perm_b32 v72, v101, v97, s64
    v_perm_b32 v76, v101, v97, s65
    v_perm_b32 v80, v102, v98, s64
    v_perm_b32 v84, v102, v98, s65
    v_perm_b32 v88, v103, v99, s64
    v_perm_b32 v92, v103, v99, s65
    s_waitcnt vmcnt(7)
    s_add_u32 s77, s74, s76
    buffer_load_dwordx4 v[136:139], v56, s[56:59], s77 offen nt
    s_add_u32 s76, s76, 1024
    s_and_b32 s76, s76, 0x7fff
    s_waitcnt vmcnt(7)
    s_add_u32 s77, s74, s76
    buffer_load_dwordx4 v[140:143], v56, s[56:59], s77 offen nt
    s_add_u32 s76, s76, 1024
    s_and_b32 s76, s76, 0x7fff
    v_perm_b32 v65, v108, v104, s64
    v_perm_b32 v69, v108, v104, s65
    v_perm_b32 v73, v109, v105, s64
    v_perm_b32 v77, v109, v105, s65
    v_perm_b32 v81, v110, v106, s64
    v_perm_b32 v85, v110, v106, s65
    v_perm_b32 v89, v111, v107, s64
    v_perm_b32 v93, v111, v107, s65
    s_waitcnt vmcnt(7)
    s_add_u32 s77, s74, s76
    buffer_load_dwordx4 v[144:147], v56, s[56:59], s77 offen nt
    s_add_u32 s76, s76, 1024
    s_and_b32 s76, s76, 0x7fff
    s_waitcnt vmcnt(7)
    s_add_u32 s77, s74, s76
    buffer_load_dwordx4 v[148:151], v56, s[56:59], s77 offen nt
    s_add_u32 s76, s76, 1024
    s_and_b32 s76, s76, 0x7fff
    v_perm_b32 v66, v116, v112, s64
    v_perm_b32 v70, v116, v112, s65
    v_perm_b32 v74, v117, v113, s64
    v_perm_b32 v78, v117, v113, s65
    v_perm_b32 v82, v118, v114, s64
    v_perm_b32 v86, v118, v114, s65
    v_perm_b32 v90, v119, v115, s64
    v_perm_b32 v94, v119, v115, s65
    s_waitcnt vmcnt(7)
    s_add_u32 s77, s74, s76
    buffer_load_dwordx4 v[152:155], v56, s[56:59], s77 offen nt
    s_add_u32 s76, s76, 1024
    s_and_b32 s76, s76, 0x7fff
    s_waitcnt vmcnt(7)
    s_cmp_lg_u32 s44, 4
    s_cbranch_scc1 L_V_nohinte0
    s_lshl_b32 s3, s2, 7
    s_add_u32 s3, s3, 327680
    s_add_u32 s4, s46, 1
    v_mov_b32 v57, s4
    v_cmp_eq_u32 vcc, 0, v0
    v_mov_b32 v58, 1073741824
    v_mov_b32 v59, 0
    v_cndmask_b32 v58, v58, v59, vcc
    buffer_store_dword v57, v58, s[52:55], s3 offen sc1
L_V_nohinte0:
    s_add_u32 s77, s74, s76
    buffer_load_dwordx4 v[156:159], v56, s[56:59], s77 offen nt
    s_add_u32 s76, s76, 1024
    s_and_b32 s76, s76, 0x7fff
    v_perm_b32 v67, v124, v120, s64
    v_perm_b32 v71, v124, v120, s65
    v_perm_b32 v75, v125, v121, s64
    v_perm_b32 v79, v125, v121, s65
    v_perm_b32 v83, v126, v122, s64
    v_perm_b32 v87, v126, v122, s65
    v_perm_b32 v91, v127, v123, s64
    v_perm_b32 v95, v127, v123, s65
    s_waitcnt vmcnt(7)
    s_add_u32 s77, s74, s76
    buffer_load_dwordx4 v[160:163], v56, s[56:59], s77 offen nt
    s_add_u32 s76, s76, 1024
    s_and_b32 s76, s76, 0x7fff
    s_waitcnt vmcnt(7)
    s_add_u32 s77, s74, s76
    buffer_load_dwordx4 v[164:167], v56, s[56:59], s77 offen nt
    s_add_u32 s76, s76, 1024
    s_and_b32 s76, s76, 0x7fff
    v_perm_b32 v96, v132, v128, s64
    v_perm_b32 v100, v132, v128, s65
    v_perm_b32 v104, v133, v129, s64
    v_perm_b32 v108, v133, v129, s65
    v_perm_b32 v112, v134, v130, s64
    v_perm_b32 v116, v134, v130, s65
    v_perm_b32 v120, v135, v131, s64
    v_perm_b32 v124, v135, v131, s65
    s_waitcnt vmcnt(7)
    s_add_u32 s77, s74, s76
    buffer_load_dwordx4 v[168:171], v56, s[56:59], s77 offen nt
    s_add_u32 s76, s76, 1024
    s_and_b32 s76, s76, 0x7fff
    s_waitcnt vmcnt(7)
    s_add_u32 s77, s74, s76
    buffer_load_dwordx4 v[172:175], v56, s[56:59], s77 offen nt
    s_add_u32 s76, s76, 1024
    s_and_b32 s76, s76, 0x7fff
    v_perm_b32 v97, v140, v136, s64
    v_perm_b32 v101, v140, v136, s65
    v_perm_b32 v105, v141, v137, s64
    v_perm_b32 v109, v141, v137, s65
    v_perm_b32 v113, v142, v138, s64
    v_perm_b32 v117, v142, v138, s65
    v_perm_b32 v121, v143, v139, s64
    v_perm_b32 v125, v143, v139, s65
    s_waitcnt vmcnt(7)
    s_add_u32 s77, s74, s76
    buffer_load_dwordx4 v[176:179], v56, s[56:59], s77 offen nt
    s_add_u32 s76, s76, 1024
    s_and_b32 s76, s76, 0x7fff
    s_waitcnt vmcnt(7)
    s_add_u32 s77, s74, s76
    buffer_load_dwordx4 v[180:183], v56, s[56:59], s77 offen nt
    s_add_u32 s76, s76, 1024
    s_and_b32 s76, s76, 0x7fff
    v_perm_b32 v98, v148, v144, s64
    v_perm_b32 v102, v148, v144, s65
    v_perm_b32 v106, v149, v145, s64
    v_perm_b32 v110, v149, v145, s65
    v_perm_b32 v114, v150, v146, s64
    v_perm_b32 v118, v150, v146, s65
    v_perm_b32 v122, v151, v147, s64
    v_perm_b32 v126, v151, v147, s65
    s_waitcnt vmcnt(7)
    s_add_u32 s77, s74, s76
    buffer_load_dwordx4 v[184:187], v56, s[56:59], s77 offen nt
    s_add_u32 s76, s76, 1024
    s_and_b32 s76, s76, 0x7fff
    s_waitcnt vmcnt(7)
    s_add_u32 s77, s74, s76
    buffer_load_dwordx4 v[188:191], v56, s[56:59], s77 offen nt
    s_add_u32 s76, s76, 1024
    s_and_b32 s76, s76, 0x7fff
    v_perm_b32 v99, v156, v152, s64
    v_perm_b32 v103, v156, v152, s65
    v_perm_b32 v107, v157, v153, s64
    v_perm_b32 v111, v157, v153, s65
    v_perm_b32 v115, v158, v154, s64
    v_perm_b32 v119, v158, v154, s65
    v_perm_b32 v123, v159, v155, s64
    v_perm_b32 v127, v159, v155, s65
    s_waitcnt vmcnt(7)
L_V_issued:
    v_lshrrev_b32 v1, 4, v0
    v_lshlrev_b32 v1, 6, v1
    v_and_b32 v2, 3, v0
    v_lshl_add_u32 v57, v2, 4, v1
    s_lshl_b32 s5, s14, 10
    s_add_u32 s5, s5, 132608
    v_add_u32 v57, s5, v57
    v_mov_b32 v4, 0x3f803f80
    v_mov_b32 v5, 0x3f803f80
    v_mov_b32 v6, 0x3f803f80
    v_mov_b32 v7, 0x3f803f80
    v_and_b32 v1, 3, v0
    v_lshlrev_b32 v1, 9, v1
    v_lshrrev_b32 v2, 4, v0
    v_lshl_add_u32 v1, v2, 4, v1
    v_bfe_u32 v2, v0, 2, 2
    v_lshl_add_u32 v1, v2, 6, v1
    s_mov_b32 s68, 0x00f000f0
    s_mov_b32 s69, 0x00f000f0
    s_mov_b32 s70, 0x0f000f00
    s_mov_b32 s71, 0x0f000f00
    s_mov_b32 s72, 0xf000f000
    s_mov_b32 s73, 0xf000f000
    s_lshl_b32 s5, s14, 11
    s_add_u32 s5, s5, 136704
    v_add_u32 v1, s5, v1
    v_and_b32 v2, 3, v0
    s_lshl_b32 s5, s14, 4
    s_add_u32 s5, s5, 132544
    v_lshlrev_b32 v2, 2, v2
    v_add_u32 v2, s5, v2
    s_barrier
    ds_read_b128 v[8:11], v57 offset:0
    ds_read_b128 v[12:15], v57 offset:256
    ds_read_b128 v[16:19], v57 offset:512
    ds_read_b128 v[20:23], v57 offset:768
    s_waitcnt lgkmcnt(0)
    v_mfma_f32_16x16x32_bf16 v[60:63], v[4:7], v[8:11], 0
    v_mfma_f32_16x16x32_bf16 v[60:63], v[4:7], v[12:15], v[60:63]
    v_mfma_f32_16x16x32_bf16 v[60:63], v[4:7], v[16:19], v[60:63]
    v_mfma_f32_16x16x32_bf16 v[60:63], v[4:7], v[20:23], v[60:63]
    v_mfma_f32_16x16x32_bf16 v[24:27], v[192:195], v[8:11], 0
    v_mfma_f32_16x16x32_bf16 v[28:31], v[196:199], v[8:11], 0
    v_mfma_f32_16x16x32_bf16 v[32:35], v[200:203], v[8:11], 0
    v_mfma_f32_16x16x32_bf16 v[36:39], v[204:207], v[8:11], 0
    v_mfma_f32_16x16x32_bf16 v[40:43], v[208:211], v[8:11], 0
    v_mfma_f32_16x16x32_bf16 v[44:47], v[212:215], v[8:11], 0
    v_mfma_f32_16x16x32_bf16 v[48:51], v[216:219], v[8:11], 0
    v_mfma_f32_16x16x32_bf16 v[52:55], v[220:223], v[8:11], 0
    v_mfma_f32_16x16x32_bf16 v[24:27], v[64:67], v[12:15], v[24:27]
    v_mfma_f32_16x16x32_bf16 v[28:31], v[68:71], v[12:15], v[28:31]
    v_mfma_f32_16x16x32_bf16 v[32:35], v[72:75], v[12:15], v[32:35]
    v_mfma_f32_16x16x32_bf16 v[36:39], v[76:79], v[12:15], v[36:39]
    v_mfma_f32_16x16x32_bf16 v[40:43], v[80:83], v[12:15], v[40:43]
    v_mfma_f32_16x16x32_bf16 v[44:47], v[84:87], v[12:15], v[44:47]
    v_mfma_f32_16x16x32_bf16 v[48:51], v[88:91], v[12:15], v[48:51]
    v_mfma_f32_16x16x32_bf16 v[52:55], v[92:95], v[12:15], v[52:55]
    v_mfma_f32_16x16x32_bf16 v[24:27], v[96:99], v[16:19], v[24:27]
    v_mfma_f32_16x16x32_bf16 v[28:31], v[100:103], v[16:19], v[28:31]
    v_mfma_f32_16x16x32_bf16 v[32:35], v[104:107], v[16:19], v[32:35]
    v_mfma_f32_16x16x32_bf16 v[36:39], v[108:111], v[16:19], v[36:39]
    v_mfma_f32_16x16x32_bf16 v[40:43], v[112:115], v[16:19], v[40:43]
    v_mfma_f32_16x16x32_bf16 v[44:47], v[116:119], v[16:19], v[44:47]
    v_mfma_f32_16x16x32_bf16 v[48:51], v[120:123], v[16:19], v[48:51]
    v_mfma_f32_16x16x32_bf16 v[52:55], v[124:127], v[16:19], v[52:55]
    s_waitcnt vmcnt(6)
    v_perm_b32 v128, v164, v160, s64
    v_perm_b32 v132, v164, v160, s65
    v_perm_b32 v136, v165, v161, s64
    v_perm_b32 v140, v165, v161, s65
    v_perm_b32 v144, v166, v162, s64
    v_perm_b32 v148, v166, v162, s65
    v_perm_b32 v152, v167, v163, s64
    v_perm_b32 v156, v167, v163, s65
    s_waitcnt vmcnt(4)
    v_perm_b32 v129, v172, v168, s64
    v_perm_b32 v133, v172, v168, s65
    v_perm_b32 v137, v173, v169, s64
    v_perm_b32 v141, v173, v169, s65
    v_perm_b32 v145, v174, v170, s64
    v_perm_b32 v149, v174, v170, s65
    v_perm_b32 v153, v175, v171, s64
    v_perm_b32 v157, v175, v171, s65
    s_waitcnt vmcnt(2)
    v_perm_b32 v130, v180, v176, s64
    v_perm_b32 v134, v180, v176, s65
    v_perm_b32 v138, v181, v177, s64
    v_perm_b32 v142, v181, v177, s65
    v_perm_b32 v146, v182, v178, s64
    v_perm_b32 v150, v182, v178, s65
    v_perm_b32 v154, v183, v179, s64
    v_perm_b32 v158, v183, v179, s65
    s_waitcnt vmcnt(0)
    v_perm_b32 v131, v188, v184, s64
    v_perm_b32 v135, v188, v184, s65
    v_perm_b32 v139, v189, v185, s64
    v_perm_b32 v143, v189, v185, s65
    v_perm_b32 v147, v190, v186, s64
    v_perm_b32 v151, v190, v186, s65
    v_perm_b32 v155, v191, v187, s64
    v_perm_b32 v159, v191, v187, s65
    v_mfma_f32_16x16x32_bf16 v[24:27], v[128:131], v[20:23], v[24:27]
    v_mfma_f32_16x16x32_bf16 v[28:31], v[132:135], v[20:23], v[28:31]
    v_mfma_f32_16x16x32_bf16 v[32:35], v[136:139], v[20:23], v[32:35]
    v_mfma_f32_16x16x32_bf16 v[36:39], v[140:143], v[20:23], v[36:39]
    v_mfma_f32_16x16x32_bf16 v[40:43], v[144:147], v[20:23], v[40:43]
    v_mfma_f32_16x16x32_bf16 v[44:47], v[148:151], v[20:23], v[44:47]
    v_mfma_f32_16x16x32_bf16 v[48:51], v[152:155], v[20:23], v[48:51]
    v_mfma_f32_16x16x32_bf16 v[52:55], v[156:159], v[20:23], v[52:55]
    s_nop 1
    v_cndmask_b32 v8, v24, v28, s[68:69]
    v_cndmask_b32 v9, v25, v29, s[68:69]
    v_cndmask_b32 v10, v26, v30, s[68:69]
    v_cndmask_b32 v11, v27, v31, s[68:69]
    v_cndmask_b32 v8, v8, v32, s[70:71]
    v_cndmask_b32 v9, v9, v33, s[70:71]
    v_cndmask_b32 v10, v10, v34, s[70:71]
    v_cndmask_b32 v11, v11, v35, s[70:71]
    v_cndmask_b32 v8, v8, v36, s[72:73]
    v_cndmask_b32 v9, v9, v37, s[72:73]
    v_cndmask_b32 v10, v10, v38, s[72:73]
    v_cndmask_b32 v11, v11, v39, s[72:73]
    ds_write_b128 v1, v[8:11] offset:0
    v_cndmask_b32 v12, v40, v44, s[68:69]
    v_cndmask_b32 v13, v41, v45, s[68:69]
    v_cndmask_b32 v14, v42, v46, s[68:69]
    v_cndmask_b32 v15, v43, v47, s[68:69]
    v_cndmask_b32 v12, v12, v48, s[70:71]
    v_cndmask_b32 v13, v13, v49, s[70:71]
    v_cndmask_b32 v14, v14, v50, s[70:71]
    v_cndmask_b32 v15, v15, v51, s[70:71]
    v_cndmask_b32 v12, v12, v52, s[72:73]
    v_cndmask_b32 v13, v13, v53, s[72:73]
    v_cndmask_b32 v14, v14, v54, s[72:73]
    v_cndmask_b32 v15, v15, v55, s[72:73]
    ds_write_b128 v1, v[12:15] offset:256
    s_mov_b32 exec_lo, 0x0000000f
    s_mov_b32 exec_hi, 0
    ds_write_b32 v2, v60
    s_mov_b64 exec, -1
    s_waitcnt lgkmcnt(0)
    s_barrier
    s_endpgm
L_chain:
    s_waitcnt lgkmcnt(0)
    s_load_dword s46, s[42:43], 0
    s_mov_b32 s52, s42
    s_mov_b32 s53, s43
    s_mov_b32 s54, 4194304
    s_mov_b32 s55, 0x00020000
    s_cmp_eq_u32 s44, 0
    s_cbranch_scc1 L_c0
    s_cmp_eq_u32 s44, 1
    s_cbranch_scc1 L_c1
    s_cmp_lt_u32 s44, 4
    s_cbranch_scc1 L_c23
    s_branch L_cidle
L_c0:
    s_cmp_ge_u32 s66, 4
    s_cbranch_scc1 L_c0_noM
    s_mov_b32 s76, s67
    s_mov_b32 s4, s66
    s_mov_b32 s48, s36
    s_mov_b32 s49, s37
    s_mov_b32 s50, 3145728
    s_mov_b32 s51, 0x00020000
    s_mov_b32 s56, s34
    s_mov_b32 s57, s35
    s_mov_b32 s58, 2048
    s_mov_b32 s59, 0x00020000
    v_and_b32 v1, 1, v0
    v_lshlrev_b32 v1, 10, v1
    v_bfe_u32 v2, v0, 1, 1
    v_lshl_add_u32 v1, v2, 4, v1
    v_lshrrev_b32 v2, 4, v0
    v_lshl_add_u32 v1, v2, 5, v1
    s_lshl_b32 s5, s4, 8
    buffer_load_dwordx4 v[8:11], v1, s[56:59], s5 offen
    buffer_load_dwordx4 v[12:15], v1, s[56:59], s5 offen offset:128
    v_lshrrev_b32 v3, 4, v0
    v_bfe_u32 v4, v0, 3, 1
    v_lshlrev_b32 v3, 4, v3
    v_lshl_add_u32 v3, v4, 3, v3
    s_mov_b32 s3, 6144
    v_mul_lo_u32 v3, v3, s3
    v_and_b32 v4, 7, v0
    v_lshl_add_u32 v2, v4, 4, v3
    s_lshl_b32 s5, s76, 7
    s_mul_i32 s6, s4, 786432
    s_add_u32 s74, s5, s6
    buffer_load_dwordx4 v[64:67], v2, s[48:51], s74 offen nt
    s_add_u32 s74, s74, 6144
    buffer_load_dwordx4 v[68:71], v2, s[48:51], s74 offen nt
    s_add_u32 s74, s74, 6144
    buffer_load_dwordx4 v[72:75], v2, s[48:51], s74 offen nt
    s_add_u32 s74, s74, 6144
    buffer_load_dwordx4 v[76:79], v2, s[48:51], s74 offen nt
    s_add_u32 s74, s74, 6144
    buffer_load_dwordx4 v[80:83], v2, s[48:51], s74 offen nt
    s_add_u32 s74, s74, 6144
    buffer_load_dwordx4 v[84:87], v2, s[48:51], s74 offen nt
    s_add_u32 s74, s74, 6144
    buffer_load_dwordx4 v[88:91], v2, s[48:51], s74 offen nt
    s_add_u32 s74, s74, 6144
    buffer_load_dwordx4 v[92:95], v2, s[48:51], s74 offen nt
    s_add_u32 s74, s74, 350208
    buffer_load_dwordx4 v[96:99], v2, s[48:51], s74 offen nt
    s_add_u32 s74, s74, 6144
    buffer_load_dwordx4 v[100:103], v2, s[48:51], s74 offen nt
    s_add_u32 s74, s74, 6144
    buffer_load_dwordx4 v[104:107], v2, s[48:51], s74 offen nt
    s_add_u32 s74, s74, 6144
    buffer_load_dwordx4 v[108:111], v2, s[48:51], s74 offen nt
    s_add_u32 s74, s74, 6144
    buffer_load_dwordx4 v[112:115], v2, s[48:51], s74 offen nt
    s_add_u32 s74, s74, 6144
    buffer_load_dwordx4 v[116:119], v2, s[48:51], s74 offen nt
    s_add_u32 s74, s74, 6144
    buffer_load_dwordx4 v[120:123], v2, s[48:51], s74 offen nt
    s_add_u32 s74, s74, 6144
    buffer_load_dwordx4 v[124:127], v2, s[48:51], s74 offen nt
    s_waitcnt vmcnt(16)
    v_lshlrev_b32 v32, 16, v8
    v_and_b32 v33, 0xffff0000, v8
    v_lshlrev_b32 v34, 16, v9
    v_and_b32 v35, 0xffff0000, v9
    v_lshlrev_b32 v36, 16, v10
    v_and_b32 v37, 0xffff0000, v10
    v_lshlrev_b32 v38, 16, v11
    v_and_b32 v39, 0xffff0000, v11
    v_lshlrev_b32 v40, 16, v12
    v_and_b32 v41, 0xffff0000, v12
    v_lshlrev_b32 v42, 16, v13
    v_and_b32 v43, 0xffff0000, v13
    v_lshlrev_b32 v44, 16, v14
    v_and_b32 v45, 0xffff0000, v14
    v_lshlrev_b32 v46, 16, v15
    v_and_b32 v47, 0xffff0000, v15
    s_mov_b32 s3, 0xbfb8aa3b
    v_mul_f32 v128, s3, v32
    v_mul_f32 v129, s3, v33
    v_mul_f32 v130, s3, v34
    v_mul_f32 v131, s3, v35
    v_mul_f32 v132, s3, v36
    v_mul_f32 v133, s3, v37
    v_mul_f32 v134, s3, v38
    v_mul_f32 v135, s3, v39
    v_mul_f32 v136, s3, v40
    v_mul_f32 v137, s3, v41
    v_mul_f32 v138, s3, v42
    v_mul_f32 v139, s3, v43
    v_mul_f32 v140, s3, v44
    v_mul_f32 v141, s3, v45
    v_mul_f32 v142, s3, v46
    v_mul_f32 v143, s3, v47
    v_exp_f32 v128, v128
    v_exp_f32 v129, v129
    v_exp_f32 v130, v130
    v_exp_f32 v131, v131
    v_exp_f32 v132, v132
    v_exp_f32 v133, v133
    v_exp_f32 v134, v134
    v_exp_f32 v135, v135
    v_exp_f32 v136, v136
    v_exp_f32 v137, v137
    v_exp_f32 v138, v138
    v_exp_f32 v139, v139
    v_exp_f32 v140, v140
    v_exp_f32 v141, v141
    v_exp_f32 v142, v142
    v_exp_f32 v143, v143
    v_add_f32 v128, 1.0, v128
    v_add_f32 v129, 1.0, v129
    v_add_f32 v130, 1.0, v130
    v_add_f32 v131, 1.0, v131
    v_add_f32 v132, 1.0, v132
    v_add_f32 v133, 1.0, v133
    v_add_f32 v134, 1.0, v134
    v_add_f32 v135, 1.0, v135
    v_add_f32 v136, 1.0, v136
    v_add_f32 v137, 1.0, v137
    v_add_f32 v138, 1.0, v138
    v_add_f32 v139, 1.0, v139
    v_add_f32 v140, 1.0, v140
    v_add_f32 v141, 1.0, v141
    v_add_f32 v142, 1.0, v142
    v_add_f32 v143, 1.0, v143
    v_rcp_f32 v128, v128
    v_rcp_f32 v129, v129
    v_rcp_f32 v130, v130
    v_rcp_f32 v131, v131
    v_rcp_f32 v132, v132
    v_rcp_f32 v133, v133
    v_rcp_f32 v134, v134
    v_rcp_f32 v135, v135
    v_rcp_f32 v136, v136
    v_rcp_f32 v137, v137
    v_rcp_f32 v138, v138
    v_rcp_f32 v139, v139
    v_rcp_f32 v140, v140
    v_rcp_f32 v141, v141
    v_rcp_f32 v142, v142
    v_rcp_f32 v143, v143
    v_mul_f32 v32, v32, v128
    v_mul_f32 v33, v33, v129
    v_mul_f32 v34, v34, v130
    v_mul_f32 v35, v35, v131
    v_mul_f32 v36, v36, v132
    v_mul_f32 v37, v37, v133
    v_mul_f32 v38, v38, v134
    v_mul_f32 v39, v39, v135
    v_mul_f32 v40, v40, v136
    v_mul_f32 v41, v41, v137
    v_mul_f32 v42, v42, v138
    v_mul_f32 v43, v43, v139
    v_mul_f32 v44, v44, v140
    v_mul_f32 v45, v45, v141
    v_mul_f32 v46, v46, v142
    v_mul_f32 v47, v47, v143
    v_cvt_pk_bf16_f32 v16, v32, v33
    v_cvt_pk_bf16_f32 v17, v34, v35
    v_cvt_pk_bf16_f32 v18, v36, v37
    v_cvt_pk_bf16_f32 v19, v38, v39
    v_cvt_pk_bf16_f32 v20, v40, v41
    v_cvt_pk_bf16_f32 v21, v42, v43
    v_cvt_pk_bf16_f32 v22, v44, v45
    v_cvt_pk_bf16_f32 v23, v46, v47
    v_bfe_u32 v3, v0, 3, 1
    s_mov_b32 s3, 256
    v_mul_lo_u32 v1, v3, s3
    v_and_b32 v3, 7, v0
    v_lshl_add_u32 v1, v3, 5, v1
    v_bfe_u32 v3, v0, 4, 1
    v_lshl_add_u32 v1, v3, 4, v1
    v_cmp_gt_u32 vcc, 32, v0
    v_mov_b32 v4, 1073741824
    s_nop 0
    v_cndmask_b32 v1, v4, v1, vcc
    v_mov_b32 v5, 0xffffff00
    s_lshl_b32 s5, s76, 2
    s_add_u32 s5, s5, s4
    s_lshl_b32 s5, s5, 9
    s_add_u32 s77, s5, 4096
    s_waitcnt lgkmcnt(0)
    s_add_u32 s45, s46, 1
    s_and_b32 s45, s45, 0xff
    s_waitcnt vmcnt(14)
    v_perm_b32 v128, v68, v64, s64
    v_perm_b32 v132, v68, v64, s65
    v_perm_b32 v136, v69, v65, s64
    v_perm_b32 v140, v69, v65, s65
    v_perm_b32 v144, v70, v66, s64
    v_perm_b32 v148, v70, v66, s65
    v_perm_b32 v152, v71, v67, s64
    v_perm_b32 v156, v71, v67, s65
    s_waitcnt vmcnt(12)
    v_perm_b32 v129, v76, v72, s64
    v_perm_b32 v133, v76, v72, s65
    v_perm_b32 v137, v77, v73, s64
    v_perm_b32 v141, v77, v73, s65
    v_perm_b32 v145, v78, v74, s64
    v_perm_b32 v149, v78, v74, s65
    v_perm_b32 v153, v79, v75, s64
    v_perm_b32 v157, v79, v75, s65
    s_waitcnt vmcnt(10)
    v_perm_b32 v130, v84, v80, s64
    v_perm_b32 v134, v84, v80, s65
    v_perm_b32 v138, v85, v81, s64
    v_perm_b32 v142, v85, v81, s65
    v_perm_b32 v146, v86, v82, s64
    v_perm_b32 v150, v86, v82, s65
    v_perm_b32 v154, v87, v83, s64
    v_perm_b32 v158, v87, v83, s65
    s_waitcnt vmcnt(8)
    v_perm_b32 v131, v92, v88, s64
    v_perm_b32 v135, v92, v88, s65
    v_perm_b32 v139, v93, v89, s64
    v_perm_b32 v143, v93, v89, s65
    v_perm_b32 v147, v94, v90, s64
    v_perm_b32 v151, v94, v90, s65
    v_perm_b32 v155, v95, v91, s64
    v_perm_b32 v159, v95, v91, s65
    s_waitcnt vmcnt(6)
    v_perm_b32 v160, v100, v96, s64
    v_perm_b32 v164, v100, v96, s65
    v_perm_b32 v168, v101, v97, s64
    v_perm_b32 v172, v101, v97, s65
    v_perm_b32 v176, v102, v98, s64
    v_perm_b32 v180, v102, v98, s65
    v_perm_b32 v184, v103, v99, s64
    v_perm_b32 v188, v103, v99, s65
    s_waitcnt vmcnt(4)
    v_perm_b32 v161, v108, v104, s64
    v_perm_b32 v165, v108, v104, s65
    v_perm_b32 v169, v109, v105, s64
    v_perm_b32 v173, v109, v105, s65
    v_perm_b32 v177, v110, v106, s64
    v_perm_b32 v181, v110, v106, s65
    v_perm_b32 v185, v111, v107, s64
    v_perm_b32 v189, v111, v107, s65
    s_waitcnt vmcnt(2)
    v_perm_b32 v162, v116, v112, s64
    v_perm_b32 v166, v116, v112, s65
    v_perm_b32 v170, v117, v113, s64
    v_perm_b32 v174, v117, v113, s65
    v_perm_b32 v178, v118, v114, s64
    v_perm_b32 v182, v118, v114, s65
    v_perm_b32 v186, v119, v115, s64
    v_perm_b32 v190, v119, v115, s65
    s_waitcnt vmcnt(0)
    v_perm_b32 v163, v124, v120, s64
    v_perm_b32 v167, v124, v120, s65
    v_perm_b32 v171, v125, v121, s64
    v_perm_b32 v175, v125, v121, s65
    v_perm_b32 v179, v126, v122, s64
    v_perm_b32 v183, v126, v122, s65
    v_perm_b32 v187, v127, v123, s64
    v_perm_b32 v191, v127, v123, s65
    v_mfma_f32_16x16x32_bf16 v[24:27], v[16:19], v[128:131], 0
    v_mfma_f32_16x16x32_bf16 v[28:31], v[16:19], v[132:135], 0
    v_mfma_f32_16x16x32_bf16 v[32:35], v[16:19], v[136:139], 0
    v_mfma_f32_16x16x32_bf16 v[36:39], v[16:19], v[140:143], 0
    v_mfma_f32_16x16x32_bf16 v[40:43], v[16:19], v[144:147], 0
    v_mfma_f32_16x16x32_bf16 v[44:47], v[16:19], v[148:151], 0
    v_mfma_f32_16x16x32_bf16 v[48:51], v[16:19], v[152:155], 0
    v_mfma_f32_16x16x32_bf16 v[52:55], v[16:19], v[156:159], 0
    v_mfma_f32_16x16x32_bf16 v[24:27], v[20:23], v[160:163], v[24:27]
    v_mfma_f32_16x16x32_bf16 v[28:31], v[20:23], v[164:167], v[28:31]
    v_mfma_f32_16x16x32_bf16 v[32:35], v[20:23], v[168:171], v[32:35]
    v_mfma_f32_16x16x32_bf16 v[36:39], v[20:23], v[172:175], v[36:39]
    v_mfma_f32_16x16x32_bf16 v[40:43], v[20:23], v[176:179], v[40:43]
    v_mfma_f32_16x16x32_bf16 v[44:47], v[20:23], v[180:183], v[44:47]
    v_mfma_f32_16x16x32_bf16 v[48:51], v[20:23], v[184:187], v[48:51]
    v_mfma_f32_16x16x32_bf16 v[52:55], v[20:23], v[188:191], v[52:55]
    s_nop 0
    v_add_f32_dpp v56, v26, v24 row_ror:8 row_mask:0x1 bank_mask:0x3
    v_add_f32_dpp v56, v25, v27 row_ror:8 row_mask:0x1 bank_mask:0xc
    v_add_f32_dpp v57, v30, v28 row_ror:8 row_mask:0x1 bank_mask:0x3
    v_add_f32_dpp v57, v29, v31 row_ror:8 row_mask:0x1 bank_mask:0xc
    v_add_f32_dpp v58, v34, v32 row_ror:8 row_mask:0x1 bank_mask:0x3
    v_add_f32_dpp v58, v33, v35 row_ror:8 row_mask:0x1 bank_mask:0xc
    v_add_f32_dpp v59, v38, v36 row_ror:8 row_mask:0x1 bank_mask:0x3
    v_add_f32_dpp v59, v37, v39 row_ror:8 row_mask:0x1 bank_mask:0xc
    v_add_f32_dpp v56, v42, v40 row_ror:8 row_mask:0x2 bank_mask:0x3
    v_add_f32_dpp v56, v41, v43 row_ror:8 row_mask:0x2 bank_mask:0xc
    v_add_f32_dpp v57, v46, v44 row_ror:8 row_mask:0x2 bank_mask:0x3
    v_add_f32_dpp v57, v45, v47 row_ror:8 row_mask:0x2 bank_mask:0xc
    v_add_f32_dpp v58, v50, v48 row_ror:8 row_mask:0x2 bank_mask:0x3
    v_add_f32_dpp v58, v49, v51 row_ror:8 row_mask:0x2 bank_mask:0xc
    v_add_f32_dpp v59, v54, v52 row_ror:8 row_mask:0x2 bank_mask:0x3
    v_add_f32_dpp v59, v53, v55 row_ror:8 row_mask:0x2 bank_mask:0xc
    v_add_u32 v56, 0x80, v56
    v_add_u32 v57, 0x80, v57
    v_add_u32 v58, 0x80, v58
    v_add_u32 v59, 0x80, v59
    v_bfi_b32 v56, v5, v56, s45
    v_bfi_b32 v57, v5, v57, s45
    v_bfi_b32 v58, v5, v58, s45
    v_bfi_b32 v59, v5, v59, s45
    buffer_store_dwordx4 v[56:59], v1, s[52:55], s77 offen sc1
L_c0_noM:
    s_waitcnt lgkmcnt(0)
    s_add_u32 s45, s46, 1
    s_and_b32 s45, s45, 0xff
    s_barrier
    s_branch L_front_done
L_c1:
L_cidle:
    s_waitcnt lgkmcnt(0)
    s_add_u32 s45, s46, 1
    s_and_b32 s45, s45, 0xff
    s_barrier
    s_branch L_front_done
L_c23:
    s_mov_b32 s48, s22
    s_mov_b32 s49, s23
    s_mov_b32 s50, 4194304
    s_mov_b32 s51, 0x00020000
    s_mov_b32 s56, s16
    s_mov_b32 s57, s17
    s_mov_b32 s58, 2048
    s_mov_b32 s59, 0x00020000
    s_lshr_b32 s8, s67, 2
    s_and_b32 s9, s67, 3
    s_lshl_b32 s9, s9, 1
    s_add_u32 s9, s9, s44
    s_sub_u32 s9, s9, 2
    s_lshl_b32 s5, s66, 3
    s_add_u32 s76, s5, s9
    s_cmp_eq_u32 s44, 2
    s_cbranch_scc0 L_c3_nox
    v_lshlrev_b32 v1, 4, v0
    buffer_load_dwordx4 v[8:11], v1, s[56:59], 0 offen
    buffer_load_dwordx4 v[12:15], v1, s[56:59], 0 offen offset:1024
    v_lshrrev_b32 v2, 5, v0
    v_lshlrev_b32 v2, 10, v2
    v_and_b32 v3, 31, v0
    v_lshl_add_u32 v2, v3, 3, v2
    s_lshl_b32 s5, s8, 8
    buffer_load_dwordx2 v[16:17], v2, s[56:59], s5 offen
L_c3_nox:
    v_lshrrev_b32 v3, 4, v0
    v_bfe_u32 v4, v0, 3, 1
    v_lshlrev_b32 v3, 4, v3
    v_lshl_add_u32 v3, v4, 3, v3
    s_mov_b32 s3, 8192
    v_mul_lo_u32 v3, v3, s3
    v_and_b32 v4, 7, v0
    v_lshl_add_u32 v2, v4, 4, v3
    s_lshl_b32 s5, s76, 7
    s_lshl_b32 s6, s8, 20
    s_add_u32 s74, s5, s6
    buffer_load_dwordx4 v[64:67], v2, s[48:51], s74 offen nt
    s_add_u32 s74, s74, 8192
    buffer_load_dwordx4 v[68:71], v2, s[48:51], s74 offen nt
    s_add_u32 s74, s74, 8192
    buffer_load_dwordx4 v[72:75], v2, s[48:51], s74 offen nt
    s_add_u32 s74, s74, 8192
    buffer_load_dwordx4 v[76:79], v2, s[48:51], s74 offen nt
    s_add_u32 s74, s74, 8192
    buffer_load_dwordx4 v[80:83], v2, s[48:51], s74 offen nt
    s_add_u32 s74, s74, 8192
    buffer_load_dwordx4 v[84:87], v2, s[48:51], s74 offen nt
    s_waitcnt vmcnt(5)
    s_add_u32 s74, s74, 8192
    buffer_load_dwordx4 v[88:91], v2, s[48:51], s74 offen nt
    s_waitcnt vmcnt(5)
    s_add_u32 s74, s74, 8192
    buffer_load_dwordx4 v[92:95], v2, s[48:51], s74 offen nt
    s_waitcnt vmcnt(5)
    s_add_u32 s74, s74, 466944
    buffer_load_dwordx4 v[96:99], v2, s[48:51], s74 offen nt
    s_waitcnt vmcnt(5)
    s_add_u32 s74, s74, 8192
    buffer_load_dwordx4 v[100:103], v2, s[48:51], s74 offen nt
    s_waitcnt vmcnt(5)
    s_add_u32 s74, s74, 8192
    buffer_load_dwordx4 v[104:107], v2, s[48:51], s74 offen nt
    s_waitcnt vmcnt(5)
    s_add_u32 s74, s74, 8192
    buffer_load_dwordx4 v[108:111], v2, s[48:51], s74 offen nt
    s_waitcnt vmcnt(5)
    s_add_u32 s74, s74, 8192
    buffer_load_dwordx4 v[112:115], v2, s[48:51], s74 offen nt
    s_waitcnt vmcnt(5)
    s_add_u32 s74, s74, 8192
    buffer_load_dwordx4 v[116:119], v2, s[48:51], s74 offen nt
    s_waitcnt vmcnt(5)
    s_add_u32 s74, s74, 8192
    buffer_load_dwordx4 v[120:123], v2, s[48:51], s74 offen nt
    s_waitcnt vmcnt(5)
    s_add_u32 s74, s74, 8192
    buffer_load_dwordx4 v[124:127], v2, s[48:51], s74 offen nt
    s_waitcnt vmcnt(5)
    v_and_b32 v7, 1, v0
    v_mul_u32_u24 v7, 384, v7
    v_bfe_u32 v3, v0, 1, 1
    v_lshl_add_u32 v7, v3, 4, v7
    v_lshrrev_b32 v3, 4, v0
    v_lshl_add_u32 v7, v3, 5, v7
    v_add_u32 v7, 3072, v7
    v_bfe_u32 v3, v0, 3, 1
    s_mov_b32 s3, 8192
    v_mul_lo_u32 v1, v3, s3
    v_and_b32 v3, 7, v0
    v_lshl_add_u32 v1, v3, 5, v1
    v_bfe_u32 v3, v0, 4, 1
    v_lshl_add_u32 v1, v3, 4, v1
    v_cmp_gt_u32 vcc, 32, v0
    v_mov_b32 v4, 1073741824
    s_nop 0
    v_cndmask_b32 v1, v4, v1, vcc
    v_mov_b32 v5, 0xffffff00
    s_lshr_b32 s5, s76, 3
    s_lshl_b32 s5, s5, 14
    s_lshl_b32 s6, s8, 11
    s_add_u32 s77, s5, s6
    s_and_b32 s4, s76, 7
    s_lshl_b32 s4, s4, 8
    s_add_u32 s77, s77, s4
    s_add_u32 s77, s77, 131072
    s_waitcnt lgkmcnt(0)
    s_add_u32 s45, s46, 1
    s_and_b32 s45, s45, 0xff
    s_cmp_eq_u32 s44, 2
    s_cbranch_scc0 L_c3_perm
    s_waitcnt vmcnt(16)
    v_lshlrev_b32 v24, 16, v8
    v_and_b32 v25, 0xffff0000, v8
    v_lshlrev_b32 v26, 16, v9
    v_and_b32 v27, 0xffff0000, v9
    v_lshlrev_b32 v28, 16, v10
    v_and_b32 v29, 0xffff0000, v10
    v_lshlrev_b32 v30, 16, v11
    v_and_b32 v31, 0xffff0000, v11
    v_lshlrev_b32 v32, 16, v12
    v_and_b32 v33, 0xffff0000, v12
    v_lshlrev_b32 v34, 16, v13
    v_and_b32 v35, 0xffff0000, v13
    v_lshlrev_b32 v36, 16, v14
    v_and_b32 v37, 0xffff0000, v14
    v_lshlrev_b32 v38, 16, v15
    v_and_b32 v39, 0xffff0000, v15
    v_add_f32 v40, v24, v25
    v_add_f32 v40, v40, v26
    v_add_f32 v40, v40, v27
    v_add_f32 v40, v40, v28
    v_add_f32 v40, v40, v29
    v_add_f32 v40, v40, v30
    v_add_f32 v40, v40, v31
    v_add_f32 v41, v32, v33
    v_add_f32 v41, v41, v34
    v_add_f32 v41, v41, v35
    v_add_f32 v41, v41, v36
    v_add_f32 v41, v41, v37
    v_add_f32 v41, v41, v38
    v_add_f32 v41, v41, v39
    v_add_f32_dpp v40, v40, v40 row_ror:1 row_mask:0xf bank_mask:0xf
    s_nop 0
    v_add_f32_dpp v41, v41, v41 row_ror:1 row_mask:0xf bank_mask:0xf
    v_add_f32_dpp v40, v40, v40 row_ror:2 row_mask:0xf bank_mask:0xf
    s_nop 0
    v_add_f32_dpp v41, v41, v41 row_ror:2 row_mask:0xf bank_mask:0xf
    v_add_f32_dpp v40, v40, v40 row_ror:4 row_mask:0xf bank_mask:0xf
    s_nop 0
    v_add_f32_dpp v41, v41, v41 row_ror:4 row_mask:0xf bank_mask:0xf
    v_add_f32_dpp v40, v40, v40 row_ror:8 row_mask:0xf bank_mask:0xf
    s_nop 0
    v_add_f32_dpp v41, v41, v41 row_ror:8 row_mask:0xf bank_mask:0xf
    s_nop 1
    v_permlane32_swap_b32 v40, v41
    v_add_f32 v40, v40, v41
    v_mov_b32 v42, v40
    s_nop 1
    v_permlane16_swap_b32 v40, v42
    v_add_f32 v40, v40, v42
    v_mul_f32 v40, 0x3b000000, v40
    s_nop 0
    v_readlane_b32 s4, v40, 0
    v_readlane_b32 s5, v40, 32
    s_nop 0
    v_subrev_f32 v24, s4, v24
    v_subrev_f32 v25, s4, v25
    v_subrev_f32 v26, s4, v26
    v_subrev_f32 v27, s4, v27
    v_subrev_f32 v28, s4, v28
    v_subrev_f32 v29, s4, v29
    v_subrev_f32 v30, s4, v30
    v_subrev_f32 v31, s4, v31
    v_subrev_f32 v32, s5, v32
    v_subrev_f32 v33, s5, v33
    v_subrev_f32 v34, s5, v34
    v_subrev_f32 v35, s5, v35
    v_subrev_f32 v36, s5, v36
    v_subrev_f32 v37, s5, v37
    v_subrev_f32 v38, s5, v38
    v_subrev_f32 v39, s5, v39
    v_mul_f32 v42, v24, v24
    v_fmac_f32 v42, v25, v25
    v_fmac_f32 v42, v26, v26
    v_fmac_f32 v42, v27, v27
    v_fmac_f32 v42, v28, v28
    v_fmac_f32 v42, v29, v29
    v_fmac_f32 v42, v30, v30
    v_fmac_f32 v42, v31, v31
    v_mul_f32 v43, v32, v32
    v_fmac_f32 v43, v33, v33
    v_fmac_f32 v43, v34, v34
    v_fmac_f32 v43, v35, v35
    v_fmac_f32 v43, v36, v36
    v_fmac_f32 v43, v37, v37
    v_fmac_f32 v43, v38, v38
    v_fmac_f32 v43, v39, v39
    v_add_f32_dpp v42, v42, v42 row_ror:1 row_mask:0xf bank_mask:0xf
    s_nop 0
    v_add_f32_dpp v43, v43, v43 row_ror:1 row_mask:0xf bank_mask:0xf
    v_add_f32_dpp v42, v42, v42 row_ror:2 row_mask:0xf bank_mask:0xf
    s_nop 0
    v_add_f32_dpp v43, v43, v43 row_ror:2 row_mask:0xf bank_mask:0xf
    v_add_f32_dpp v42, v42, v42 row_ror:4 row_mask:0xf bank_mask:0xf
    s_nop 0
    v_add_f32_dpp v43, v43, v43 row_ror:4 row_mask:0xf bank_mask:0xf
    v_add_f32_dpp v42, v42, v42 row_ror:8 row_mask:0xf bank_mask:0xf
    s_nop 0
    v_add_f32_dpp v43, v43, v43 row_ror:8 row_mask:0xf bank_mask:0xf
    s_nop 1
    v_permlane32_swap_b32 v42, v43
    v_add_f32 v42, v42, v43
    v_mov_b32 v44, v42
    s_nop 1
    v_permlane16_swap_b32 v42, v44
    v_add_f32 v42, v42, v44
    v_mul_f32 v41, 0x3b000000, v42
    v_lshlrev_b32 v44, 16, v16
    v_and_b32 v45, 0xffff0000, v16
    v_lshlrev_b32 v46, 16, v17
    v_and_b32 v47, 0xffff0000, v17
    v_bfe_u32 v6, v0, 4, 1
    v_lshlrev_b32 v6, 11, v6
    v_lshrrev_b32 v3, 5, v0
    v_lshl_add_u32 v6, v3, 8, v6
    v_and_b32 v3, 15, v0
    v_lshl_add_u32 v6, v3, 4, v6
    s_lshl_b32 s5, s8, 12
    s_add_u32 s9, s5, 4096
    s_add_u32 s10, s9, 16384
    v_lshrrev_b32 v18, 5, v0
    v_mul_u32_u24 v18, 384, v18
    v_and_b32 v3, 31, v0
    v_lshl_add_u32 v18, v3, 3, v18
    v_add_u32 v18, 3072, v18
    s_waitcnt vmcnt(14)
    v_perm_b32 v128, v68, v64, s64
    v_perm_b32 v132, v68, v64, s65
    v_perm_b32 v136, v69, v65, s64
    v_perm_b32 v140, v69, v65, s65
    v_perm_b32 v144, v70, v66, s64
    v_perm_b32 v148, v70, v66, s65
    v_perm_b32 v152, v71, v67, s64
    v_perm_b32 v156, v71, v67, s65
    s_waitcnt vmcnt(12)
    v_perm_b32 v129, v76, v72, s64
    v_perm_b32 v133, v76, v72, s65
    v_perm_b32 v137, v77, v73, s64
    v_perm_b32 v141, v77, v73, s65
    v_perm_b32 v145, v78, v74, s64
    v_perm_b32 v149, v78, v74, s65
    v_perm_b32 v153, v79, v75, s64
    v_perm_b32 v157, v79, v75, s65
    s_waitcnt vmcnt(10)
    v_perm_b32 v130, v84, v80, s64
    v_perm_b32 v134, v84, v80, s65
    v_perm_b32 v138, v85, v81, s64
    v_perm_b32 v142, v85, v81, s65
    v_perm_b32 v146, v86, v82, s64
    v_perm_b32 v150, v86, v82, s65
    v_perm_b32 v154, v87, v83, s64
    v_perm_b32 v158, v87, v83, s65
    s_waitcnt vmcnt(8)
    v_perm_b32 v131, v92, v88, s64
    v_perm_b32 v135, v92, v88, s65
    v_perm_b32 v139, v93, v89, s64
    v_perm_b32 v143, v93, v89, s65
    v_perm_b32 v147, v94, v90, s64
    v_perm_b32 v151, v94, v90, s65
    v_perm_b32 v155, v95, v91, s64
    v_perm_b32 v159, v95, v91, s65
    s_waitcnt vmcnt(6)
    v_perm_b32 v160, v100, v96, s64
    v_perm_b32 v164, v100, v96, s65
    v_perm_b32 v168, v101, v97, s64
    v_perm_b32 v172, v101, v97, s65
    v_perm_b32 v176, v102, v98, s64
    v_perm_b32 v180, v102, v98, s65
    v_perm_b32 v184, v103, v99, s64
    v_perm_b32 v188, v103, v99, s65
    s_waitcnt vmcnt(4)
    v_perm_b32 v161, v108, v104, s64
    v_perm_b32 v165, v108, v104, s65
    v_perm_b32 v169, v109, v105, s64
    v_perm_b32 v173, v109, v105, s65
    v_perm_b32 v177, v110, v106, s64
    v_perm_b32 v181, v110, v106, s65
    v_perm_b32 v185, v111, v107, s64
    v_perm_b32 v189, v111, v107, s65
    s_waitcnt vmcnt(2)
    v_perm_b32 v162, v116, v112, s64
    v_perm_b32 v166, v116, v112, s65
    v_perm_b32 v170, v117, v113, s64
    v_perm_b32 v174, v117, v113, s65
    v_perm_b32 v178, v118, v114, s64
    v_perm_b32 v182, v118, v114, s65
    v_perm_b32 v186, v119, v115, s64
    v_perm_b32 v190, v119, v115, s65
    s_waitcnt vmcnt(0)
    v_perm_b32 v163, v124, v120, s64
    v_perm_b32 v167, v124, v120, s65
    v_perm_b32 v171, v125, v121, s64
    v_perm_b32 v175, v125, v121, s65
    v_perm_b32 v179, v126, v122, s64
    v_perm_b32 v183, v126, v122, s65
    v_perm_b32 v187, v127, v123, s64
    v_perm_b32 v191, v127, v123, s65
L_c2_h1:
    buffer_load_dwordx4 v[64:67], v6, s[52:55], s9 offen offset:0 sc1
    buffer_load_dwordx4 v[68:71], v6, s[52:55], s9 offen offset:512 sc1
    buffer_load_dwordx4 v[72:75], v6, s[52:55], s9 offen offset:1024 sc1
    buffer_load_dwordx4 v[76:79], v6, s[52:55], s9 offen offset:1536 sc1
    buffer_load_dwordx4 v[80:83], v6, s[52:55], s10 offen offset:0 sc1
    buffer_load_dwordx4 v[84:87], v6, s[52:55], s10 offen offset:512 sc1
    buffer_load_dwordx4 v[88:91], v6, s[52:55], s10 offen offset:1024 sc1
    buffer_load_dwordx4 v[92:95], v6, s[52:55], s10 offen offset:1536 sc1
    s_waitcnt vmcnt(0)
    v_bitop3_b32 v96, v64, v65, s45 bitop3:0x7e
    v_bitop3_b32 v97, v66, v67, s45 bitop3:0x7e
    v_bitop3_b32 v98, v68, v69, s45 bitop3:0x7e
    v_bitop3_b32 v99, v70, v71, s45 bitop3:0x7e
    v_bitop3_b32 v100, v72, v73, s45 bitop3:0x7e
    v_bitop3_b32 v101, v74, v75, s45 bitop3:0x7e
    v_bitop3_b32 v102, v76, v77, s45 bitop3:0x7e
    v_bitop3_b32 v103, v78, v79, s45 bitop3:0x7e
    v_bitop3_b32 v104, v80, v81, s45 bitop3:0x7e
    v_bitop3_b32 v105, v82, v83, s45 bitop3:0x7e
    v_bitop3_b32 v106, v84, v85, s45 bitop3:0x7e
    v_bitop3_b32 v107, v86, v87, s45 bitop3:0x7e
    v_bitop3_b32 v108, v88, v89, s45 bitop3:0x7e
    v_bitop3_b32 v109, v90, v91, s45 bitop3:0x7e
    v_bitop3_b32 v110, v92, v93, s45 bitop3:0x7e
    v_bitop3_b32 v111, v94, v95, s45 bitop3:0x7e
    v_or3_b32 v96, v96, v97, v98
    v_or3_b32 v99, v99, v100, v101
    v_or3_b32 v102, v102, v103, v104
    v_or3_b32 v105, v105, v106, v107
    v_or3_b32 v108, v108, v109, v110
    v_or3_b32 v96, v96, v99, v102
    v_or3_b32 v105, v105, v108, v111
    v_or_b32 v96, v96, v105
    v_and_b32 v96, 0xff, v96
    v_cmp_ne_u32 vcc, 0, v96
    s_cbranch_vccz L_c2_h1_ok
    s_sub_u32 s47, s47, 1
    s_cmp_gt_i32 s47, 0
    s_cbranch_scc1 L_c2_h1
L_c2_h1_ok:
    v_and_b32 v64, 0xffffff00, v64
    v_and_b32 v65, 0xffffff00, v65
    v_and_b32 v66, 0xffffff00, v66
    v_and_b32 v67, 0xffffff00, v67
    v_and_b32 v68, 0xffffff00, v68
    v_and_b32 v69, 0xffffff00, v69
    v_and_b32 v70, 0xffffff00, v70
    v_and_b32 v71, 0xffffff00, v71
    v_and_b32 v72, 0xffffff00, v72
    v_and_b32 v73, 0xffffff00, v73
    v_and_b32 v74, 0xffffff00, v74
    v_and_b32 v75, 0xffffff00, v75
    v_and_b32 v76, 0xffffff00, v76
    v_and_b32 v77, 0xffffff00, v77
    v_and_b32 v78, 0xffffff00, v78
    v_and_b32 v79, 0xffffff00, v79
    v_and_b32 v80, 0xffffff00, v80
    v_and_b32 v81, 0xffffff00, v81
    v_and_b32 v82, 0xffffff00, v82
    v_and_b32 v83, 0xffffff00, v83
    v_and_b32 v84, 0xffffff00, v84
    v_and_b32 v85, 0xffffff00, v85
    v_and_b32 v86, 0xffffff00, v86
    v_and_b32 v87, 0xffffff00, v87
    v_and_b32 v88, 0xffffff00, v88
    v_and_b32 v89, 0xffffff00, v89
    v_and_b32 v90, 0xffffff00, v90
    v_and_b32 v91, 0xffffff00, v91
    v_and_b32 v92, 0xffffff00, v92
    v_and_b32 v93, 0xffffff00, v93
    v_and_b32 v94, 0xffffff00, v94
    v_and_b32 v95, 0xffffff00, v95
    v_pk_add_f32 v[64:65], v[64:65], v[68:69]
    v_pk_add_f32 v[66:67], v[66:67], v[70:71]
    v_pk_add_f32 v[72:73], v[72:73], v[76:77]
    v_pk_add_f32 v[74:75], v[74:75], v[78:79]
    v_pk_add_f32 v[64:65], v[64:65], v[72:73]
    v_pk_add_f32 v[66:67], v[66:67], v[74:75]
    v_pk_add_f32 v[80:81], v[80:81], v[84:85]
    v_pk_add_f32 v[82:83], v[82:83], v[86:87]
    v_pk_add_f32 v[88:89], v[88:89], v[92:93]
    v_pk_add_f32 v[90:91], v[90:91], v[94:95]
    v_pk_add_f32 v[80:81], v[80:81], v[88:89]
    v_pk_add_f32 v[82:83], v[82:83], v[90:91]
    v_cvt_pk_bf16_f32 v96, v64, v65
    v_cvt_pk_bf16_f32 v97, v66, v67
    v_lshlrev_b32 v64, 16, v96
    v_and_b32 v65, 0xffff0000, v96
    v_lshlrev_b32 v66, 16, v97
    v_and_b32 v67, 0xffff0000, v97
    v_cvt_pk_bf16_f32 v96, v80, v81
    v_cvt_pk_bf16_f32 v97, v82, v83
    v_lshlrev_b32 v80, 16, v96
    v_and_b32 v81, 0xffff0000, v96
    v_lshlrev_b32 v82, 16, v97
    v_and_b32 v83, 0xffff0000, v97
    v_add_f32 v80, 1.0, v80
    v_add_f32 v81, 1.0, v81
    v_add_f32 v82, 1.0, v82
    v_add_f32 v83, 1.0, v83
    v_cvt_pk_bf16_f32 v96, v80, v81
    v_cvt_pk_bf16_f32 v97, v82, v83
    v_lshlrev_b32 v80, 16, v96
    v_and_b32 v81, 0xffff0000, v96
    v_lshlrev_b32 v82, 16, v97
    v_and_b32 v83, 0xffff0000, v97
    v_cvt_pk_bf16_f32 v96, v40, v41
    v_lshlrev_b32 v40, 16, v96
    v_and_b32 v41, 0xffff0000, v96
    v_add_f32 v41, 0x3727c5ac, v41
    v_cvt_pk_bf16_f32 v96, v41, v41
    v_lshlrev_b32 v41, 16, v96
    v_sqrt_f32 v41, v41
    s_nop 0
    v_cvt_pk_bf16_f32 v96, v41, v41
    v_lshlrev_b32 v41, 16, v96
    v_rcp_f32 v102, v41
    v_sub_f32 v44, v44, v40
    v_sub_f32 v45, v45, v40
    v_sub_f32 v46, v46, v40
    v_sub_f32 v47, v47, v40
    v_cvt_pk_bf16_f32 v96, v44, v45
    v_cvt_pk_bf16_f32 v97, v46, v47
    v_lshlrev_b32 v44, 16, v96
    v_and_b32 v45, 0xffff0000, v96
    v_lshlrev_b32 v46, 16, v97
    v_and_b32 v47, 0xffff0000, v97
    v_mul_f32 v104, v44, v102
    v_mul_f32 v105, v45, v102
    v_mul_f32 v106, v46, v102
    v_mul_f32 v107, v47, v102
    v_fma_f32 v44, -v104, v41, v44
    v_fma_f32 v45, -v105, v41, v45
    v_fma_f32 v46, -v106, v41, v46
    v_fma_f32 v47, -v107, v41, v47
    v_fma_f32 v44, v44, v102, v104
    v_fma_f32 v45, v45, v102, v105
    v_fma_f32 v46, v46, v102, v106
    v_fma_f32 v47, v47, v102, v107
    v_cvt_pk_bf16_f32 v96, v44, v45
    v_cvt_pk_bf16_f32 v97, v46, v47
    v_lshlrev_b32 v44, 16, v96
    v_and_b32 v45, 0xffff0000, v96
    v_lshlrev_b32 v46, 16, v97
    v_and_b32 v47, 0xffff0000, v97
    v_mul_f32 v44, v44, v80
    v_mul_f32 v45, v45, v81
    v_mul_f32 v46, v46, v82
    v_mul_f32 v47, v47, v83
    v_cvt_pk_bf16_f32 v96, v44, v45
    v_cvt_pk_bf16_f32 v97, v46, v47
    v_lshlrev_b32 v44, 16, v96
    v_and_b32 v45, 0xffff0000, v96
    v_lshlrev_b32 v46, 16, v97
    v_and_b32 v47, 0xffff0000, v97
    v_add_f32 v44, v44, v64
    v_add_f32 v45, v45, v65
    v_add_f32 v46, v46, v66
    v_add_f32 v47, v47, v67
    v_cvt_pk_bf16_f32 v100, v44, v45
    v_cvt_pk_bf16_f32 v101, v46, v47
    ds_write_b64 v18, v[100:101]
    s_waitcnt lgkmcnt(0)
    s_branch L_c23_go
L_c3_perm:
    s_waitcnt vmcnt(14)
    v_perm_b32 v128, v68, v64, s64
    v_perm_b32 v132, v68, v64, s65
    v_perm_b32 v136, v69, v65, s64
    v_perm_b32 v140, v69, v65, s65
    v_perm_b32 v144, v70, v66, s64
    v_perm_b32 v148, v70, v66, s65
    v_perm_b32 v152, v71, v67, s64
    v_perm_b32 v156, v71, v67, s65
    s_waitcnt vmcnt(12)
    v_perm_b32 v129, v76, v72, s64
    v_perm_b32 v133, v76, v72, s65
    v_perm_b32 v137, v77, v73, s64
    v_perm_b32 v141, v77, v73, s65
    v_perm_b32 v145, v78, v74, s64
    v_perm_b32 v149, v78, v74, s65
    v_perm_b32 v153, v79, v75, s64
    v_perm_b32 v157, v79, v75, s65
    s_waitcnt vmcnt(10)
    v_perm_b32 v130, v84, v80, s64
    v_perm_b32 v134, v84, v80, s65
    v_perm_b32 v138, v85, v81, s64
    v_perm_b32 v142, v85, v81, s65
    v_perm_b32 v146, v86, v82, s64
    v_perm_b32 v150, v86, v82, s65
    v_perm_b32 v154, v87, v83, s64
    v_perm_b32 v158, v87, v83, s65
    s_waitcnt vmcnt(8)
    v_perm_b32 v131, v92, v88, s64
    v_perm_b32 v135, v92, v88, s65
    v_perm_b32 v139, v93, v89, s64
    v_perm_b32 v143, v93, v89, s65
    v_perm_b32 v147, v94, v90, s64
    v_perm_b32 v151, v94, v90, s65
    v_perm_b32 v155, v95, v91, s64
    v_perm_b32 v159, v95, v91, s65
    s_waitcnt vmcnt(6)
    v_perm_b32 v160, v100, v96, s64
    v_perm_b32 v164, v100, v96, s65
    v_perm_b32 v168, v101, v97, s64
    v_perm_b32 v172, v101, v97, s65
    v_perm_b32 v176, v102, v98, s64
    v_perm_b32 v180, v102, v98, s65
    v_perm_b32 v184, v103, v99, s64
    v_perm_b32 v188, v103, v99, s65
    s_waitcnt vmcnt(4)
    v_perm_b32 v161, v108, v104, s64
    v_perm_b32 v165, v108, v104, s65
    v_perm_b32 v169, v109, v105, s64
    v_perm_b32 v173, v109, v105, s65
    v_perm_b32 v177, v110, v106, s64
    v_perm_b32 v181, v110, v106, s65
    v_perm_b32 v185, v111, v107, s64
    v_perm_b32 v189, v111, v107, s65
    s_waitcnt vmcnt(2)
    v_perm_b32 v162, v116, v112, s64
    v_perm_b32 v166, v116, v112, s65
    v_perm_b32 v170, v117, v113, s64
    v_perm_b32 v174, v117, v113, s65
    v_perm_b32 v178, v118, v114, s64
    v_perm_b32 v182, v118, v114, s65
    v_perm_b32 v186, v119, v115, s64
    v_perm_b32 v190, v119, v115, s65
    s_waitcnt vmcnt(0)
    v_perm_b32 v163, v124, v120, s64
    v_perm_b32 v167, v124, v120, s65
    v_perm_b32 v171, v125, v121, s64
    v_perm_b32 v175, v125, v121, s65
    v_perm_b32 v179, v126, v122, s64
    v_perm_b32 v183, v126, v122, s65
    v_perm_b32 v187, v127, v123, s64
    v_perm_b32 v191, v127, v123, s65
L_c23_go:
    s_barrier
    ds_read_b128 v[16:19], v7
    ds_read_b128 v[20:23], v7 offset:128
    s_waitcnt lgkmcnt(0)
    v_mfma_f32_16x16x32_bf16 v[24:27], v[16:19], v[128:131], 0
    v_mfma_f32_16x16x32_bf16 v[28:31], v[16:19], v[132:135], 0
    v_mfma_f32_16x16x32_bf16 v[32:35], v[16:19], v[136:139], 0
    v_mfma_f32_16x16x32_bf16 v[36:39], v[16:19], v[140:143], 0
    v_mfma_f32_16x16x32_bf16 v[40:43], v[16:19], v[144:147], 0
    v_mfma_f32_16x16x32_bf16 v[44:47], v[16:19], v[148:151], 0
    v_mfma_f32_16x16x32_bf16 v[48:51], v[16:19], v[152:155], 0
    v_mfma_f32_16x16x32_bf16 v[52:55], v[16:19], v[156:159], 0
    v_mfma_f32_16x16x32_bf16 v[24:27], v[20:23], v[160:163], v[24:27]
    v_mfma_f32_16x16x32_bf16 v[28:31], v[20:23], v[164:167], v[28:31]
    v_mfma_f32_16x16x32_bf16 v[32:35], v[20:23], v[168:171], v[32:35]
    v_mfma_f32_16x16x32_bf16 v[36:39], v[20:23], v[172:175], v[36:39]
    v_mfma_f32_16x16x32_bf16 v[40:43], v[20:23], v[176:179], v[40:43]
    v_mfma_f32_16x16x32_bf16 v[44:47], v[20:23], v[180:183], v[44:47]
    v_mfma_f32_16x16x32_bf16 v[48:51], v[20:23], v[184:187], v[48:51]
    v_mfma_f32_16x16x32_bf16 v[52:55], v[20:23], v[188:191], v[52:55]
    s_nop 0
    v_add_f32_dpp v56, v26, v24 row_ror:8 row_mask:0x1 bank_mask:0x3
    v_add_f32_dpp v56, v25, v27 row_ror:8 row_mask:0x1 bank_mask:0xc
    v_add_f32_dpp v57, v30, v28 row_ror:8 row_mask:0x1 bank_mask:0x3
    v_add_f32_dpp v57, v29, v31 row_ror:8 row_mask:0x1 bank_mask:0xc
    v_add_f32_dpp v58, v34, v32 row_ror:8 row_mask:0x1 bank_mask:0x3
    v_add_f32_dpp v58, v33, v35 row_ror:8 row_mask:0x1 bank_mask:0xc
    v_add_f32_dpp v59, v38, v36 row_ror:8 row_mask:0x1 bank_mask:0x3
    v_add_f32_dpp v59, v37, v39 row_ror:8 row_mask:0x1 bank_mask:0xc
    v_add_f32_dpp v56, v42, v40 row_ror:8 row_mask:0x2 bank_mask:0x3
    v_add_f32_dpp v56, v41, v43 row_ror:8 row_mask:0x2 bank_mask:0xc
    v_add_f32_dpp v57, v46, v44 row_ror:8 row_mask:0x2 bank_mask:0x3
    v_add_f32_dpp v57, v45, v47 row_ror:8 row_mask:0x2 bank_mask:0xc
    v_add_f32_dpp v58, v50, v48 row_ror:8 row_mask:0x2 bank_mask:0x3
    v_add_f32_dpp v58, v49, v51 row_ror:8 row_mask:0x2 bank_mask:0xc
    v_add_f32_dpp v59, v54, v52 row_ror:8 row_mask:0x2 bank_mask:0x3
    v_add_f32_dpp v59, v53, v55 row_ror:8 row_mask:0x2 bank_mask:0xc
    v_add_u32 v56, 0x80, v56
    v_add_u32 v57, 0x80, v57
    v_add_u32 v58, 0x80, v58
    v_add_u32 v59, 0x80, v59
    v_bfi_b32 v56, v5, v56, s45
    v_bfi_b32 v57, v5, v57, s45
    v_bfi_b32 v58, v5, v58, s45
    v_bfi_b32 v59, v5, v59, s45
    s_add_u32 s12, s77, 1048576
    buffer_store_dwordx4 v[56:59], v1, s[52:55], s12 offen
    buffer_store_dwordx4 v[56:59], v1, s[52:55], s77 offen sc1
    s_branch L_front_done
L_front_done:
    s_cmp_eq_u32 s67, 15
    s_cbranch_scc0 L_notidle
    s_lshr_b32 s5, s66, 2
    s_lshl_b32 s5, s5, 3
    s_add_u32 s76, s5, s44
    s_add_u32 s76, s76, 32
    s_and_b32 s4, s66, 3
    s_mov_b32 s48, s36
    s_mov_b32 s49, s37
    s_mov_b32 s50, 3145728
    s_mov_b32 s51, 0x00020000
    s_mov_b32 s56, s34
    s_mov_b32 s57, s35
    s_mov_b32 s58, 2048
    s_mov_b32 s59, 0x00020000
    v_and_b32 v1, 1, v0
    v_lshlrev_b32 v1, 10, v1
    v_bfe_u32 v2, v0, 1, 1
    v_lshl_add_u32 v1, v2, 4, v1
    v_lshrrev_b32 v2, 4, v0
    v_lshl_add_u32 v1, v2, 5, v1
    s_lshl_b32 s5, s4, 8
    buffer_load_dwordx4 v[8:11], v1, s[56:59], s5 offen
    buffer_load_dwordx4 v[12:15], v1, s[56:59], s5 offen offset:128
    v_lshrrev_b32 v3, 4, v0
    v_bfe_u32 v4, v0, 3, 1
    v_lshlrev_b32 v3, 4, v3
    v_lshl_add_u32 v3, v4, 3, v3
    s_mov_b32 s3, 6144
    v_mul_lo_u32 v3, v3, s3
    v_and_b32 v4, 7, v0
    v_lshl_add_u32 v2, v4, 4, v3
    s_lshl_b32 s5, s76, 7
    s_mul_i32 s6, s4, 786432
    s_add_u32 s74, s5, s6
    buffer_load_dwordx4 v[64:67], v2, s[48:51], s74 offen nt
    s_add_u32 s74, s74, 6144
    buffer_load_dwordx4 v[68:71], v2, s[48:51], s74 offen nt
    s_add_u32 s74, s74, 6144
    buffer_load_dwordx4 v[72:75], v2, s[48:51], s74 offen nt
    s_add_u32 s74, s74, 6144
    buffer_load_dwordx4 v[76:79], v2, s[48:51], s74 offen nt
    s_add_u32 s74, s74, 6144
    buffer_load_dwordx4 v[80:83], v2, s[48:51], s74 offen nt
    s_add_u32 s74, s74, 6144
    buffer_load_dwordx4 v[84:87], v2, s[48:51], s74 offen nt
    s_add_u32 s74, s74, 6144
    buffer_load_dwordx4 v[88:91], v2, s[48:51], s74 offen nt
    s_add_u32 s74, s74, 6144
    buffer_load_dwordx4 v[92:95], v2, s[48:51], s74 offen nt
    s_add_u32 s74, s74, 350208
    buffer_load_dwordx4 v[96:99], v2, s[48:51], s74 offen nt
    s_add_u32 s74, s74, 6144
    buffer_load_dwordx4 v[100:103], v2, s[48:51], s74 offen nt
    s_add_u32 s74, s74, 6144
    buffer_load_dwordx4 v[104:107], v2, s[48:51], s74 offen nt
    s_add_u32 s74, s74, 6144
    buffer_load_dwordx4 v[108:111], v2, s[48:51], s74 offen nt
    s_add_u32 s74, s74, 6144
    buffer_load_dwordx4 v[112:115], v2, s[48:51], s74 offen nt
    s_add_u32 s74, s74, 6144
    buffer_load_dwordx4 v[116:119], v2, s[48:51], s74 offen nt
    s_add_u32 s74, s74, 6144
    buffer_load_dwordx4 v[120:123], v2, s[48:51], s74 offen nt
    s_add_u32 s74, s74, 6144
    buffer_load_dwordx4 v[124:127], v2, s[48:51], s74 offen nt
    s_waitcnt vmcnt(16)
    v_lshlrev_b32 v32, 16, v8
    v_and_b32 v33, 0xffff0000, v8
    v_lshlrev_b32 v34, 16, v9
    v_and_b32 v35, 0xffff0000, v9
    v_lshlrev_b32 v36, 16, v10
    v_and_b32 v37, 0xffff0000, v10
    v_lshlrev_b32 v38, 16, v11
    v_and_b32 v39, 0xffff0000, v11
    v_lshlrev_b32 v40, 16, v12
    v_and_b32 v41, 0xffff0000, v12
    v_lshlrev_b32 v42, 16, v13
    v_and_b32 v43, 0xffff0000, v13
    v_lshlrev_b32 v44, 16, v14
    v_and_b32 v45, 0xffff0000, v14
    v_lshlrev_b32 v46, 16, v15
    v_and_b32 v47, 0xffff0000, v15
    s_mov_b32 s3, 0xbfb8aa3b
    v_mul_f32 v128, s3, v32
    v_mul_f32 v129, s3, v33
    v_mul_f32 v130, s3, v34
    v_mul_f32 v131, s3, v35
    v_mul_f32 v132, s3, v36
    v_mul_f32 v133, s3, v37
    v_mul_f32 v134, s3, v38
    v_mul_f32 v135, s3, v39
    v_mul_f32 v136, s3, v40
    v_mul_f32 v137, s3, v41
    v_mul_f32 v138, s3, v42
    v_mul_f32 v139, s3, v43
    v_mul_f32 v140, s3, v44
    v_mul_f32 v141, s3, v45
    v_mul_f32 v142, s3, v46
    v_mul_f32 v143, s3, v47
    v_exp_f32 v128, v128
    v_exp_f32 v129, v129
    v_exp_f32 v130, v130
    v_exp_f32 v131, v131
    v_exp_f32 v132, v132
    v_exp_f32 v133, v133
    v_exp_f32 v134, v134
    v_exp_f32 v135, v135
    v_exp_f32 v136, v136
    v_exp_f32 v137, v137
    v_exp_f32 v138, v138
    v_exp_f32 v139, v139
    v_exp_f32 v140, v140
    v_exp_f32 v141, v141
    v_exp_f32 v142, v142
    v_exp_f32 v143, v143
    v_add_f32 v128, 1.0, v128
    v_add_f32 v129, 1.0, v129
    v_add_f32 v130, 1.0, v130
    v_add_f32 v131, 1.0, v131
    v_add_f32 v132, 1.0, v132
    v_add_f32 v133, 1.0, v133
    v_add_f32 v134, 1.0, v134
    v_add_f32 v135, 1.0, v135
    v_add_f32 v136, 1.0, v136
    v_add_f32 v137, 1.0, v137
    v_add_f32 v138, 1.0, v138
    v_add_f32 v139, 1.0, v139
    v_add_f32 v140, 1.0, v140
    v_add_f32 v141, 1.0, v141
    v_add_f32 v142, 1.0, v142
    v_add_f32 v143, 1.0, v143
    v_rcp_f32 v128, v128
    v_rcp_f32 v129, v129
    v_rcp_f32 v130, v130
    v_rcp_f32 v131, v131
    v_rcp_f32 v132, v132
    v_rcp_f32 v133, v133
    v_rcp_f32 v134, v134
    v_rcp_f32 v135, v135
    v_rcp_f32 v136, v136
    v_rcp_f32 v137, v137
    v_rcp_f32 v138, v138
    v_rcp_f32 v139, v139
    v_rcp_f32 v140, v140
    v_rcp_f32 v141, v141
    v_rcp_f32 v142, v142
    v_rcp_f32 v143, v143
    v_mul_f32 v32, v32, v128
    v_mul_f32 v33, v33, v129
    v_mul_f32 v34, v34, v130
    v_mul_f32 v35, v35, v131
    v_mul_f32 v36, v36, v132
    v_mul_f32 v37, v37, v133
    v_mul_f32 v38, v38, v134
    v_mul_f32 v39, v39, v135
    v_mul_f32 v40, v40, v136
    v_mul_f32 v41, v41, v137
    v_mul_f32 v42, v42, v138
    v_mul_f32 v43, v43, v139
    v_mul_f32 v44, v44, v140
    v_mul_f32 v45, v45, v141
    v_mul_f32 v46, v46, v142
    v_mul_f32 v47, v47, v143
    v_cvt_pk_bf16_f32 v16, v32, v33
    v_cvt_pk_bf16_f32 v17, v34, v35
    v_cvt_pk_bf16_f32 v18, v36, v37
    v_cvt_pk_bf16_f32 v19, v38, v39
    v_cvt_pk_bf16_f32 v20, v40, v41
    v_cvt_pk_bf16_f32 v21, v42, v43
    v_cvt_pk_bf16_f32 v22, v44, v45
    v_cvt_pk_bf16_f32 v23, v46, v47
    v_bfe_u32 v3, v0, 3, 1
    s_mov_b32 s3, 256
    v_mul_lo_u32 v1, v3, s3
    v_and_b32 v3, 7, v0
    v_lshl_add_u32 v1, v3, 5, v1
    v_bfe_u32 v3, v0, 4, 1
    v_lshl_add_u32 v1, v3, 4, v1
    v_cmp_gt_u32 vcc, 32, v0
    v_mov_b32 v4, 1073741824
    s_nop 0
    v_cndmask_b32 v1, v4, v1, vcc
    v_mov_b32 v5, 0xffffff00
    s_lshl_b32 s5, s76, 2
    s_add_u32 s5, s5, s4
    s_lshl_b32 s5, s5, 9
    s_add_u32 s77, s5, 4096
    s_waitcnt lgkmcnt(0)
    s_add_u32 s45, s46, 1
    s_and_b32 s45, s45, 0xff
    s_waitcnt vmcnt(14)
    v_perm_b32 v128, v68, v64, s64
    v_perm_b32 v132, v68, v64, s65
    v_perm_b32 v136, v69, v65, s64
    v_perm_b32 v140, v69, v65, s65
    v_perm_b32 v144, v70, v66, s64
    v_perm_b32 v148, v70, v66, s65
    v_perm_b32 v152, v71, v67, s64
    v_perm_b32 v156, v71, v67, s65
    s_waitcnt vmcnt(12)
    v_perm_b32 v129, v76, v72, s64
    v_perm_b32 v133, v76, v72, s65
    v_perm_b32 v137, v77, v73, s64
    v_perm_b32 v141, v77, v73, s65
    v_perm_b32 v145, v78, v74, s64
    v_perm_b32 v149, v78, v74, s65
    v_perm_b32 v153, v79, v75, s64
    v_perm_b32 v157, v79, v75, s65
    s_waitcnt vmcnt(10)
    v_perm_b32 v130, v84, v80, s64
    v_perm_b32 v134, v84, v80, s65
    v_perm_b32 v138, v85, v81, s64
    v_perm_b32 v142, v85, v81, s65
    v_perm_b32 v146, v86, v82, s64
    v_perm_b32 v150, v86, v82, s65
    v_perm_b32 v154, v87, v83, s64
    v_perm_b32 v158, v87, v83, s65
    s_waitcnt vmcnt(8)
    v_perm_b32 v131, v92, v88, s64
    v_perm_b32 v135, v92, v88, s65
    v_perm_b32 v139, v93, v89, s64
    v_perm_b32 v143, v93, v89, s65
    v_perm_b32 v147, v94, v90, s64
    v_perm_b32 v151, v94, v90, s65
    v_perm_b32 v155, v95, v91, s64
    v_perm_b32 v159, v95, v91, s65
    s_waitcnt vmcnt(6)
    v_perm_b32 v160, v100, v96, s64
    v_perm_b32 v164, v100, v96, s65
    v_perm_b32 v168, v101, v97, s64
    v_perm_b32 v172, v101, v97, s65
    v_perm_b32 v176, v102, v98, s64
    v_perm_b32 v180, v102, v98, s65
    v_perm_b32 v184, v103, v99, s64
    v_perm_b32 v188, v103, v99, s65
    s_waitcnt vmcnt(4)
    v_perm_b32 v161, v108, v104, s64
    v_perm_b32 v165, v108, v104, s65
    v_perm_b32 v169, v109, v105, s64
    v_perm_b32 v173, v109, v105, s65
    v_perm_b32 v177, v110, v106, s64
    v_perm_b32 v181, v110, v106, s65
    v_perm_b32 v185, v111, v107, s64
    v_perm_b32 v189, v111, v107, s65
    s_waitcnt vmcnt(2)
    v_perm_b32 v162, v116, v112, s64
    v_perm_b32 v166, v116, v112, s65
    v_perm_b32 v170, v117, v113, s64
    v_perm_b32 v174, v117, v113, s65
    v_perm_b32 v178, v118, v114, s64
    v_perm_b32 v182, v118, v114, s65
    v_perm_b32 v186, v119, v115, s64
    v_perm_b32 v190, v119, v115, s65
    s_waitcnt vmcnt(0)
    v_perm_b32 v163, v124, v120, s64
    v_perm_b32 v167, v124, v120, s65
    v_perm_b32 v171, v125, v121, s64
    v_perm_b32 v175, v125, v121, s65
    v_perm_b32 v179, v126, v122, s64
    v_perm_b32 v183, v126, v122, s65
    v_perm_b32 v187, v127, v123, s64
    v_perm_b32 v191, v127, v123, s65
    v_mfma_f32_16x16x32_bf16 v[24:27], v[16:19], v[128:131], 0
    v_mfma_f32_16x16x32_bf16 v[28:31], v[16:19], v[132:135], 0
    v_mfma_f32_16x16x32_bf16 v[32:35], v[16:19], v[136:139], 0
    v_mfma_f32_16x16x32_bf16 v[36:39], v[16:19], v[140:143], 0
    v_mfma_f32_16x16x32_bf16 v[40:43], v[16:19], v[144:147], 0
    v_mfma_f32_16x16x32_bf16 v[44:47], v[16:19], v[148:151], 0
    v_mfma_f32_16x16x32_bf16 v[48:51], v[16:19], v[152:155], 0
    v_mfma_f32_16x16x32_bf16 v[52:55], v[16:19], v[156:159], 0
    v_mfma_f32_16x16x32_bf16 v[24:27], v[20:23], v[160:163], v[24:27]
    v_mfma_f32_16x16x32_bf16 v[28:31], v[20:23], v[164:167], v[28:31]
    v_mfma_f32_16x16x32_bf16 v[32:35], v[20:23], v[168:171], v[32:35]
    v_mfma_f32_16x16x32_bf16 v[36:39], v[20:23], v[172:175], v[36:39]
    v_mfma_f32_16x16x32_bf16 v[40:43], v[20:23], v[176:179], v[40:43]
    v_mfma_f32_16x16x32_bf16 v[44:47], v[20:23], v[180:183], v[44:47]
    v_mfma_f32_16x16x32_bf16 v[48:51], v[20:23], v[184:187], v[48:51]
    v_mfma_f32_16x16x32_bf16 v[52:55], v[20:23], v[188:191], v[52:55]
    s_nop 0
    v_add_f32_dpp v56, v26, v24 row_ror:8 row_mask:0x1 bank_mask:0x3
    v_add_f32_dpp v56, v25, v27 row_ror:8 row_mask:0x1 bank_mask:0xc
    v_add_f32_dpp v57, v30, v28 row_ror:8 row_mask:0x1 bank_mask:0x3
    v_add_f32_dpp v57, v29, v31 row_ror:8 row_mask:0x1 bank_mask:0xc
    v_add_f32_dpp v58, v34, v32 row_ror:8 row_mask:0x1 bank_mask:0x3
    v_add_f32_dpp v58, v33, v35 row_ror:8 row_mask:0x1 bank_mask:0xc
    v_add_f32_dpp v59, v38, v36 row_ror:8 row_mask:0x1 bank_mask:0x3
    v_add_f32_dpp v59, v37, v39 row_ror:8 row_mask:0x1 bank_mask:0xc
    v_add_f32_dpp v56, v42, v40 row_ror:8 row_mask:0x2 bank_mask:0x3
    v_add_f32_dpp v56, v41, v43 row_ror:8 row_mask:0x2 bank_mask:0xc
    v_add_f32_dpp v57, v46, v44 row_ror:8 row_mask:0x2 bank_mask:0x3
    v_add_f32_dpp v57, v45, v47 row_ror:8 row_mask:0x2 bank_mask:0xc
    v_add_f32_dpp v58, v50, v48 row_ror:8 row_mask:0x2 bank_mask:0x3
    v_add_f32_dpp v58, v49, v51 row_ror:8 row_mask:0x2 bank_mask:0xc
    v_add_f32_dpp v59, v54, v52 row_ror:8 row_mask:0x2 bank_mask:0x3
    v_add_f32_dpp v59, v53, v55 row_ror:8 row_mask:0x2 bank_mask:0xc
    v_add_u32 v56, 0x80, v56
    v_add_u32 v57, 0x80, v57
    v_add_u32 v58, 0x80, v58
    v_add_u32 v59, 0x80, v59
    v_bfi_b32 v56, v5, v56, s45
    v_bfi_b32 v57, v5, v57, s45
    v_bfi_b32 v58, v5, v58, s45
    v_bfi_b32 v59, v5, v59, s45
    buffer_store_dwordx4 v[56:59], v1, s[52:55], s77 offen sc1
    s_endpgm
L_notidle:
    s_cmp_eq_u32 s44, 6
    s_cbranch_scc0 L_hint_done
    s_lshl_b32 s3, s67, 10
    s_add_u32 s13, s3, 327680
    s_add_u32 s12, s46, 1
    v_and_b32 v1, 7, v0
    v_lshlrev_b32 v1, 7, v1
    s_cmp_ge_u32 s67, 8
    s_cselect_b32 s3, 0x4000, 0
    s_add_u32 s13, s13, s3
L_c6_hint:
    buffer_load_dword v2, v1, s[52:55], s13 offen sc1
    s_waitcnt vmcnt(0)
    v_cmp_eq_u32 vcc, s12, v2
    s_cbranch_vccnz L_hint_done
    s_sleep 2
    s_sub_u32 s47, s47, 1
    s_cmp_gt_i32 s47, 0
    s_cbranch_scc1 L_c6_hint
L_hint_done:
    s_barrier
    s_cmp_lt_u32 s67, 8
    s_cbranch_scc0 L_nomr6
    s_cmp_eq_u32 s44, 4
    s_cbranch_scc0 L_nomr5
    s_setprio 3
    s_lshr_b32 s5, s66, 2
    s_lshl_b32 s5, s5, 3
    s_add_u32 s76, s5, s67
    s_add_u32 s76, s76, 16
    s_and_b32 s4, s66, 3
    s_mov_b32 s48, s36
    s_mov_b32 s49, s37
    s_mov_b32 s50, 3145728
    s_mov_b32 s51, 0x00020000
    s_mov_b32 s56, s34
    s_mov_b32 s57, s35
    s_mov_b32 s58, 2048
    s_mov_b32 s59, 0x00020000
    v_and_b32 v1, 1, v0
    v_lshlrev_b32 v1, 10, v1
    v_bfe_u32 v2, v0, 1, 1
    v_lshl_add_u32 v1, v2, 4, v1
    v_lshrrev_b32 v2, 4, v0
    v_lshl_add_u32 v1, v2, 5, v1
    s_lshl_b32 s5, s4, 8
    buffer_load_dwordx4 v[8:11], v1, s[56:59], s5 offen
    buffer_load_dwordx4 v[12:15], v1, s[56:59], s5 offen offset:128
    v_lshrrev_b32 v3, 4, v0
    v_bfe_u32 v4, v0, 3, 1
    v_lshlrev_b32 v3, 4, v3
    v_lshl_add_u32 v3, v4, 3, v3
    s_mov_b32 s3, 6144
    v_mul_lo_u32 v3, v3, s3
    v_and_b32 v4, 7, v0
    v_lshl_add_u32 v2, v4, 4, v3
    s_lshl_b32 s5, s76, 7
    s_mul_i32 s6, s4, 786432
    s_add_u32 s74, s5, s6
    buffer_load_dwordx4 v[64:67], v2, s[48:51], s74 offen nt
    s_add_u32 s74, s74, 6144
    buffer_load_dwordx4 v[68:71], v2, s[48:51], s74 offen nt
    s_add_u32 s74, s74, 6144
    buffer_load_dwordx4 v[72:75], v2, s[48:51], s74 offen nt
    s_add_u32 s74, s74, 6144
    buffer_load_dwordx4 v[76:79], v2, s[48:51], s74 offen nt
    s_add_u32 s74, s74, 6144
    buffer_load_dwordx4 v[80:83], v2, s[48:51], s74 offen nt
    s_add_u32 s74, s74, 6144
    buffer_load_dwordx4 v[84:87], v2, s[48:51], s74 offen nt
    s_add_u32 s74, s74, 6144
    buffer_load_dwordx4 v[88:91], v2, s[48:51], s74 offen nt
    s_add_u32 s74, s74, 6144
    buffer_load_dwordx4 v[92:95], v2, s[48:51], s74 offen nt
    s_add_u32 s74, s74, 350208
    buffer_load_dwordx4 v[96:99], v2, s[48:51], s74 offen nt
    s_add_u32 s74, s74, 6144
    buffer_load_dwordx4 v[100:103], v2, s[48:51], s74 offen nt
    s_add_u32 s74, s74, 6144
    buffer_load_dwordx4 v[104:107], v2, s[48:51], s74 offen nt
    s_add_u32 s74, s74, 6144
    buffer_load_dwordx4 v[108:111], v2, s[48:51], s74 offen nt
    s_add_u32 s74, s74, 6144
    buffer_load_dwordx4 v[112:115], v2, s[48:51], s74 offen nt
    s_add_u32 s74, s74, 6144
    buffer_load_dwordx4 v[116:119], v2, s[48:51], s74 offen nt
    s_add_u32 s74, s74, 6144
    buffer_load_dwordx4 v[120:123], v2, s[48:51], s74 offen nt
    s_add_u32 s74, s74, 6144
    buffer_load_dwordx4 v[124:127], v2, s[48:51], s74 offen nt
    s_barrier
    s_waitcnt vmcnt(16)
    v_lshlrev_b32 v32, 16, v8
    v_and_b32 v33, 0xffff0000, v8
    v_lshlrev_b32 v34, 16, v9
    v_and_b32 v35, 0xffff0000, v9
    v_lshlrev_b32 v36, 16, v10
    v_and_b32 v37, 0xffff0000, v10
    v_lshlrev_b32 v38, 16, v11
    v_and_b32 v39, 0xffff0000, v11
    v_lshlrev_b32 v40, 16, v12
    v_and_b32 v41, 0xffff0000, v12
    v_lshlrev_b32 v42, 16, v13
    v_and_b32 v43, 0xffff0000, v13
    v_lshlrev_b32 v44, 16, v14
    v_and_b32 v45, 0xffff0000, v14
    v_lshlrev_b32 v46, 16, v15
    v_and_b32 v47, 0xffff0000, v15
    s_mov_b32 s3, 0xbfb8aa3b
    v_mul_f32 v128, s3, v32
    v_mul_f32 v129, s3, v33
    v_mul_f32 v130, s3, v34
    v_mul_f32 v131, s3, v35
    v_mul_f32 v132, s3, v36
    v_mul_f32 v133, s3, v37
    v_mul_f32 v134, s3, v38
    v_mul_f32 v135, s3, v39
    v_mul_f32 v136, s3, v40
    v_mul_f32 v137, s3, v41
    v_mul_f32 v138, s3, v42
    v_mul_f32 v139, s3, v43
    v_mul_f32 v140, s3, v44
    v_mul_f32 v141, s3, v45
    v_mul_f32 v142, s3, v46
    v_mul_f32 v143, s3, v47
    v_exp_f32 v128, v128
    v_exp_f32 v129, v129
    v_exp_f32 v130, v130
    v_exp_f32 v131, v131
    v_exp_f32 v132, v132
    v_exp_f32 v133, v133
    v_exp_f32 v134, v134
    v_exp_f32 v135, v135
    v_exp_f32 v136, v136
    v_exp_f32 v137, v137
    v_exp_f32 v138, v138
    v_exp_f32 v139, v139
    v_exp_f32 v140, v140
    v_exp_f32 v141, v141
    v_exp_f32 v142, v142
    v_exp_f32 v143, v143
    v_add_f32 v128, 1.0, v128
    v_add_f32 v129, 1.0, v129
    v_add_f32 v130, 1.0, v130
    v_add_f32 v131, 1.0, v131
    v_add_f32 v132, 1.0, v132
    v_add_f32 v133, 1.0, v133
    v_add_f32 v134, 1.0, v134
    v_add_f32 v135, 1.0, v135
    v_add_f32 v136, 1.0, v136
    v_add_f32 v137, 1.0, v137
    v_add_f32 v138, 1.0, v138
    v_add_f32 v139, 1.0, v139
    v_add_f32 v140, 1.0, v140
    v_add_f32 v141, 1.0, v141
    v_add_f32 v142, 1.0, v142
    v_add_f32 v143, 1.0, v143
    v_rcp_f32 v128, v128
    v_rcp_f32 v129, v129
    v_rcp_f32 v130, v130
    v_rcp_f32 v131, v131
    v_rcp_f32 v132, v132
    v_rcp_f32 v133, v133
    v_rcp_f32 v134, v134
    v_rcp_f32 v135, v135
    v_rcp_f32 v136, v136
    v_rcp_f32 v137, v137
    v_rcp_f32 v138, v138
    v_rcp_f32 v139, v139
    v_rcp_f32 v140, v140
    v_rcp_f32 v141, v141
    v_rcp_f32 v142, v142
    v_rcp_f32 v143, v143
    v_mul_f32 v32, v32, v128
    v_mul_f32 v33, v33, v129
    v_mul_f32 v34, v34, v130
    v_mul_f32 v35, v35, v131
    v_mul_f32 v36, v36, v132
    v_mul_f32 v37, v37, v133
    v_mul_f32 v38, v38, v134
    v_mul_f32 v39, v39, v135
    v_mul_f32 v40, v40, v136
    v_mul_f32 v41, v41, v137
    v_mul_f32 v42, v42, v138
    v_mul_f32 v43, v43, v139
    v_mul_f32 v44, v44, v140
    v_mul_f32 v45, v45, v141
    v_mul_f32 v46, v46, v142
    v_mul_f32 v47, v47, v143
    v_cvt_pk_bf16_f32 v16, v32, v33
    v_cvt_pk_bf16_f32 v17, v34, v35
    v_cvt_pk_bf16_f32 v18, v36, v37
    v_cvt_pk_bf16_f32 v19, v38, v39
    v_cvt_pk_bf16_f32 v20, v40, v41
    v_cvt_pk_bf16_f32 v21, v42, v43
    v_cvt_pk_bf16_f32 v22, v44, v45
    v_cvt_pk_bf16_f32 v23, v46, v47
    v_bfe_u32 v3, v0, 3, 1
    s_mov_b32 s3, 256
    v_mul_lo_u32 v1, v3, s3
    v_and_b32 v3, 7, v0
    v_lshl_add_u32 v1, v3, 5, v1
    v_bfe_u32 v3, v0, 4, 1
    v_lshl_add_u32 v1, v3, 4, v1
    v_cmp_gt_u32 vcc, 32, v0
    v_mov_b32 v4, 1073741824
    s_nop 0
    v_cndmask_b32 v1, v4, v1, vcc
    v_mov_b32 v5, 0xffffff00
    s_lshl_b32 s5, s76, 2
    s_add_u32 s5, s5, s4
    s_lshl_b32 s5, s5, 9
    s_add_u32 s77, s5, 4096
    s_waitcnt lgkmcnt(0)
    s_add_u32 s45, s46, 1
    s_and_b32 s45, s45, 0xff
    s_waitcnt vmcnt(14)
    v_perm_b32 v128, v68, v64, s64
    v_perm_b32 v132, v68, v64, s65
    v_perm_b32 v136, v69, v65, s64
    v_perm_b32 v140, v69, v65, s65
    v_perm_b32 v144, v70, v66, s64
    v_perm_b32 v148, v70, v66, s65
    v_perm_b32 v152, v71, v67, s64
    v_perm_b32 v156, v71, v67, s65
    s_waitcnt vmcnt(12)
    v_perm_b32 v129, v76, v72, s64
    v_perm_b32 v133, v76, v72, s65
    v_perm_b32 v137, v77, v73, s64
    v_perm_b32 v141, v77, v73, s65
    v_perm_b32 v145, v78, v74, s64
    v_perm_b32 v149, v78, v74, s65
    v_perm_b32 v153, v79, v75, s64
    v_perm_b32 v157, v79, v75, s65
    s_waitcnt vmcnt(10)
    v_perm_b32 v130, v84, v80, s64
    v_perm_b32 v134, v84, v80, s65
    v_perm_b32 v138, v85, v81, s64
    v_perm_b32 v142, v85, v81, s65
    v_perm_b32 v146, v86, v82, s64
    v_perm_b32 v150, v86, v82, s65
    v_perm_b32 v154, v87, v83, s64
    v_perm_b32 v158, v87, v83, s65
    s_waitcnt vmcnt(8)
    v_perm_b32 v131, v92, v88, s64
    v_perm_b32 v135, v92, v88, s65
    v_perm_b32 v139, v93, v89, s64
    v_perm_b32 v143, v93, v89, s65
    v_perm_b32 v147, v94, v90, s64
    v_perm_b32 v151, v94, v90, s65
    v_perm_b32 v155, v95, v91, s64
    v_perm_b32 v159, v95, v91, s65
    s_waitcnt vmcnt(6)
    v_perm_b32 v160, v100, v96, s64
    v_perm_b32 v164, v100, v96, s65
    v_perm_b32 v168, v101, v97, s64
    v_perm_b32 v172, v101, v97, s65
    v_perm_b32 v176, v102, v98, s64
    v_perm_b32 v180, v102, v98, s65
    v_perm_b32 v184, v103, v99, s64
    v_perm_b32 v188, v103, v99, s65
    s_waitcnt vmcnt(4)
    v_perm_b32 v161, v108, v104, s64
    v_perm_b32 v165, v108, v104, s65
    v_perm_b32 v169, v109, v105, s64
    v_perm_b32 v173, v109, v105, s65
    v_perm_b32 v177, v110, v106, s64
    v_perm_b32 v181, v110, v106, s65
    v_perm_b32 v185, v111, v107, s64
    v_perm_b32 v189, v111, v107, s65
    s_waitcnt vmcnt(2)
    v_perm_b32 v162, v116, v112, s64
    v_perm_b32 v166, v116, v112, s65
    v_perm_b32 v170, v117, v113, s64
    v_perm_b32 v174, v117, v113, s65
    v_perm_b32 v178, v118, v114, s64
    v_perm_b32 v182, v118, v114, s65
    v_perm_b32 v186, v119, v115, s64
    v_perm_b32 v190, v119, v115, s65
    s_waitcnt vmcnt(0)
    v_perm_b32 v163, v124, v120, s64
    v_perm_b32 v167, v124, v120, s65
    v_perm_b32 v171, v125, v121, s64
    v_perm_b32 v175, v125, v121, s65
    v_perm_b32 v179, v126, v122, s64
    v_perm_b32 v183, v126, v122, s65
    v_perm_b32 v187, v127, v123, s64
    v_perm_b32 v191, v127, v123, s65
    v_mfma_f32_16x16x32_bf16 v[24:27], v[16:19], v[128:131], 0
    v_mfma_f32_16x16x32_bf16 v[28:31], v[16:19], v[132:135], 0
    v_mfma_f32_16x16x32_bf16 v[32:35], v[16:19], v[136:139], 0
    v_mfma_f32_16x16x32_bf16 v[36:39], v[16:19], v[140:143], 0
    v_mfma_f32_16x16x32_bf16 v[40:43], v[16:19], v[144:147], 0
    v_mfma_f32_16x16x32_bf16 v[44:47], v[16:19], v[148:151], 0
    v_mfma_f32_16x16x32_bf16 v[48:51], v[16:19], v[152:155], 0
    v_mfma_f32_16x16x32_bf16 v[52:55], v[16:19], v[156:159], 0
    v_mfma_f32_16x16x32_bf16 v[24:27], v[20:23], v[160:163], v[24:27]
    v_mfma_f32_16x16x32_bf16 v[28:31], v[20:23], v[164:167], v[28:31]
    v_mfma_f32_16x16x32_bf16 v[32:35], v[20:23], v[168:171], v[32:35]
    v_mfma_f32_16x16x32_bf16 v[36:39], v[20:23], v[172:175], v[36:39]
    v_mfma_f32_16x16x32_bf16 v[40:43], v[20:23], v[176:179], v[40:43]
    v_mfma_f32_16x16x32_bf16 v[44:47], v[20:23], v[180:183], v[44:47]
    v_mfma_f32_16x16x32_bf16 v[48:51], v[20:23], v[184:187], v[48:51]
    v_mfma_f32_16x16x32_bf16 v[52:55], v[20:23], v[188:191], v[52:55]
    s_nop 0
    v_add_f32_dpp v56, v26, v24 row_ror:8 row_mask:0x1 bank_mask:0x3
    v_add_f32_dpp v56, v25, v27 row_ror:8 row_mask:0x1 bank_mask:0xc
    v_add_f32_dpp v57, v30, v28 row_ror:8 row_mask:0x1 bank_mask:0x3
    v_add_f32_dpp v57, v29, v31 row_ror:8 row_mask:0x1 bank_mask:0xc
    v_add_f32_dpp v58, v34, v32 row_ror:8 row_mask:0x1 bank_mask:0x3
    v_add_f32_dpp v58, v33, v35 row_ror:8 row_mask:0x1 bank_mask:0xc
    v_add_f32_dpp v59, v38, v36 row_ror:8 row_mask:0x1 bank_mask:0x3
    v_add_f32_dpp v59, v37, v39 row_ror:8 row_mask:0x1 bank_mask:0xc
    v_add_f32_dpp v56, v42, v40 row_ror:8 row_mask:0x2 bank_mask:0x3
    v_add_f32_dpp v56, v41, v43 row_ror:8 row_mask:0x2 bank_mask:0xc
    v_add_f32_dpp v57, v46, v44 row_ror:8 row_mask:0x2 bank_mask:0x3
    v_add_f32_dpp v57, v45, v47 row_ror:8 row_mask:0x2 bank_mask:0xc
    v_add_f32_dpp v58, v50, v48 row_ror:8 row_mask:0x2 bank_mask:0x3
    v_add_f32_dpp v58, v49, v51 row_ror:8 row_mask:0x2 bank_mask:0xc
    v_add_f32_dpp v59, v54, v52 row_ror:8 row_mask:0x2 bank_mask:0x3
    v_add_f32_dpp v59, v53, v55 row_ror:8 row_mask:0x2 bank_mask:0xc
    v_add_u32 v56, 0x80, v56
    v_add_u32 v57, 0x80, v57
    v_add_u32 v58, 0x80, v58
    v_add_u32 v59, 0x80, v59
    v_bfi_b32 v56, v5, v56, s45
    v_bfi_b32 v57, v5, v57, s45
    v_bfi_b32 v58, v5, v58, s45
    v_bfi_b32 v59, v5, v59, s45
    buffer_store_dwordx4 v[56:59], v1, s[52:55], s77 offen sc1
    s_setprio 0
    s_branch L_nomr6
L_nomr5:
    s_barrier
L_nomr6:
    s_cmp_lt_u32 s67, 8
    s_cbranch_scc1 L_otype
    s_cmp_lt_u32 s67, 15
    s_cbranch_scc1 L_ftype
    s_endpgm
L_otype:
    s_cmp_lt_u32 s44, 4
    s_cbranch_scc1 L_o03
    s_cmp_eq_u32 s44, 4
    s_cbranch_scc1 L_o4
    s_cmp_eq_u32 s44, 5
    s_cbranch_scc1 L_o_sync
L_o4:
L_o_sync:
    s_lshr_b32 s3, s44, 1
    s_and_b32 s5, s44, 1
    s_lshl_b32 s4, s66, 2
    s_add_u32 s4, s4, s3
    s_lshl_b32 s6, s4, 1
    s_add_u32 s6, s6, s5
    s_lshl_b32 s6, s6, 12
    s_add_u32 s78, s6, 524288
    v_lshrrev_b32 v203, 3, v0
    v_and_b32 v204, 7, v0
    v_lshlrev_b32 v200, 9, v203
    v_lshl_add_u32 v200, v204, 4, v200
    s_lshl_b32 s4, s5, 7
    s_lshl_b32 s6, s3, 5
    s_add_u32 s4, s4, s6
    s_add_u32 s4, s4, 3840
    v_lshlrev_b32 v201, 2, v203
    v_add_u32 v201, s4, v201
    s_mul_i32 s5, s5, 384
    s_mul_i32 s3, s3, 768
    s_add_u32 s5, s5, s3
    s_add_u32 s5, s5, 0
    v_bfe_u32 v202, v0, 4, 1
    v_bfe_u32 v205, v0, 5, 1
    v_lshlrev_b32 v202, 2, v202
    v_lshl_add_u32 v202, v205, 1, v202
    v_lshl_add_u32 v202, v204, 3, v202
    v_add_u32 v202, s5, v202
    s_lshr_b32 s3, s44, 1
    s_and_b32 s5, s44, 1
    s_lshl_b32 s6, s66, 1
    s_add_u32 s6, s6, s5
    s_lshl_b32 s6, s6, 10
    s_lshl_b32 s3, s3, 4
    s_add_u32 s79, s6, s3
    s_add_u32 s79, s79, 262144
    s_add_u32 s12, s46, 1
    v_lshlrev_b32 v228, 7, v203
    s_mov_b32 s75, 1048576
    s_mov_b32 s76, 400
    s_add_u32 s79, s79, s75
    s_add_u32 s78, s78, s75
L_o47_h3_ml:
    s_cmp_eq_u32 s76, 0
    s_cbranch_scc0 L_o47_h3_go
    s_sub_u32 s79, s79, s75
    s_sub_u32 s78, s78, s75
    s_mov_b32 s75, 0
L_o47_h3_go:
    s_sub_u32 s76, s76, 1
    buffer_load_dwordx4 v[224:227], v228, s[52:55], s79 offen sc1
    s_waitcnt vmcnt(0)
    v_bitop3_b32 v229, v224, v225, s45 bitop3:0x7e
    v_and_b32 v229, 0xff, v229
    v_xor_b32 v226, s12, v226
    v_or_b32 v229, v229, v226
    v_cmp_ne_u32 vcc, 0, v229
    s_cbranch_vccz L_o47_h3_ml_ok
    s_sub_u32 s47, s47, 1
    s_cmp_gt_i32 s47, 0
    s_cbranch_scc1 L_o47_h3_ml
L_o47_h3_ml_ok:
    buffer_load_dwordx4 v[208:211], v200, s[52:55], s78 offen offset:0 sc1
    buffer_load_dwordx4 v[212:215], v200, s[52:55], s78 offen offset:128 sc1
    buffer_load_dwordx4 v[216:219], v200, s[52:55], s78 offen offset:256 sc1
    buffer_load_dwordx4 v[220:223], v200, s[52:55], s78 offen offset:384 sc1
    v_and_b32 v224, 0xffffff00, v224
    v_and_b32 v225, 0xffffff00, v225
    v_mov_b32 v230, v224
    s_nop 1
    v_max_f32_dpp v230, v230, v230 row_ror:8 row_mask:0xf bank_mask:0xf
    v_mov_b32 v231, v230
    s_nop 1
    v_permlane16_swap_b32 v230, v231
    v_max_f32 v230, v230, v231
    v_mov_b32 v231, v230
    s_nop 1
    v_permlane32_swap_b32 v230, v231
    v_max_f32 v230, v230, v231
    s_mov_b32 s3, 0x3fb8aa3b
    v_sub_f32 v224, v224, v230
    v_mul_f32 v224, s3, v224
    v_exp_f32 v224, v224
    s_nop 0
    v_mul_f32 v225, v224, v225
    s_nop 1
    v_add_f32_dpp v225, v225, v225 row_ror:8 row_mask:0xf bank_mask:0xf
    v_mov_b32 v231, v225
    s_nop 1
    v_permlane16_swap_b32 v225, v231
    v_add_f32 v225, v225, v231
    v_mov_b32 v231, v225
    s_nop 1
    v_permlane32_swap_b32 v225, v231
    v_add_f32 v225, v225, v231
    v_rcp_f32 v225, v225
    s_nop 0
    v_mul_f32 v206, v224, v225
    s_branch L_o47_h3_wait
L_o47_h3:
    buffer_load_dwordx4 v[208:211], v200, s[52:55], s78 offen offset:0 sc1
    buffer_load_dwordx4 v[212:215], v200, s[52:55], s78 offen offset:128 sc1
    buffer_load_dwordx4 v[216:219], v200, s[52:55], s78 offen offset:256 sc1
    buffer_load_dwordx4 v[220:223], v200, s[52:55], s78 offen offset:384 sc1
L_o47_h3_wait:
    s_waitcnt vmcnt(0)
    v_bitop3_b32 v224, v208, v209, s45 bitop3:0x7e
    v_bitop3_b32 v225, v210, v211, s45 bitop3:0x7e
    v_bitop3_b32 v226, v212, v213, s45 bitop3:0x7e
    v_bitop3_b32 v227, v214, v215, s45 bitop3:0x7e
    v_bitop3_b32 v228, v216, v217, s45 bitop3:0x7e
    v_bitop3_b32 v229, v218, v219, s45 bitop3:0x7e
    v_bitop3_b32 v230, v220, v221, s45 bitop3:0x7e
    v_bitop3_b32 v231, v222, v223, s45 bitop3:0x7e
    v_or3_b32 v224, v224, v225, v226
    v_or3_b32 v227, v227, v228, v229
    v_or_b32 v230, v230, v231
    v_or3_b32 v224, v224, v227, v230
    v_and_b32 v224, 0xff, v224
    v_cmp_ne_u32 vcc, 0, v224
    s_cbranch_vccz L_o47_h3_ok
    s_sub_u32 s47, s47, 1
    s_cmp_gt_i32 s47, 0
    s_cbranch_scc1 L_o47_h3
L_o47_h3_ok:
    v_and_b32 v208, 0xffffff00, v208
    v_and_b32 v209, 0xffffff00, v209
    v_and_b32 v210, 0xffffff00, v210
    v_and_b32 v211, 0xffffff00, v211
    v_and_b32 v212, 0xffffff00, v212
    v_and_b32 v213, 0xffffff00, v213
    v_and_b32 v214, 0xffffff00, v214
    v_and_b32 v215, 0xffffff00, v215
    v_and_b32 v216, 0xffffff00, v216
    v_and_b32 v217, 0xffffff00, v217
    v_and_b32 v218, 0xffffff00, v218
    v_and_b32 v219, 0xffffff00, v219
    v_and_b32 v220, 0xffffff00, v220
    v_and_b32 v221, 0xffffff00, v221
    v_and_b32 v222, 0xffffff00, v222
    v_and_b32 v223, 0xffffff00, v223
    v_pk_mul_f32 v[208:209], v[208:209], v[206:207] op_sel_hi:[1,0]
    v_pk_mul_f32 v[210:211], v[210:211], v[206:207] op_sel_hi:[1,0]
    v_pk_mul_f32 v[212:213], v[212:213], v[206:207] op_sel_hi:[1,0]
    v_pk_mul_f32 v[214:215], v[214:215], v[206:207] op_sel_hi:[1,0]
    v_pk_mul_f32 v[216:217], v[216:217], v[206:207] op_sel_hi:[1,0]
    v_pk_mul_f32 v[218:219], v[218:219], v[206:207] op_sel_hi:[1,0]
    v_pk_mul_f32 v[220:221], v[220:221], v[206:207] op_sel_hi:[1,0]
    v_pk_mul_f32 v[222:223], v[222:223], v[206:207] op_sel_hi:[1,0]
    v_permlane32_swap_b32 v208, v209
    v_permlane32_swap_b32 v210, v211
    v_permlane32_swap_b32 v212, v213
    v_permlane32_swap_b32 v214, v215
    v_permlane32_swap_b32 v216, v217
    v_permlane32_swap_b32 v218, v219
    v_permlane32_swap_b32 v220, v221
    v_permlane32_swap_b32 v222, v223
    v_add_f32 v208, v208, v209
    v_add_f32 v210, v210, v211
    v_add_f32 v212, v212, v213
    v_add_f32 v214, v214, v215
    v_add_f32 v216, v216, v217
    v_add_f32 v218, v218, v219
    v_add_f32 v220, v220, v221
    v_add_f32 v222, v222, v223
    v_permlane16_swap_b32 v208, v210
    v_permlane16_swap_b32 v212, v214
    v_permlane16_swap_b32 v216, v218
    v_permlane16_swap_b32 v220, v222
    v_add_f32 v208, v208, v210
    v_add_f32 v212, v212, v214
    v_add_f32 v216, v216, v218
    v_add_f32 v220, v220, v222
    v_add_f32_dpp v208, v208, v208 row_ror:8 row_mask:0xf bank_mask:0xf
    v_add_f32_dpp v212, v212, v212 row_ror:8 row_mask:0xf bank_mask:0xf
    v_add_f32_dpp v216, v216, v216 row_ror:8 row_mask:0xf bank_mask:0xf
    v_add_f32_dpp v220, v220, v220 row_ror:8 row_mask:0xf bank_mask:0xf
    v_cvt_pk_bf16_f32 v208, v208, v208
    v_cvt_pk_bf16_f32 v212, v212, v212
    v_cvt_pk_bf16_f32 v216, v216, v216
    v_cvt_pk_bf16_f32 v220, v220, v220
    ds_write_b16 v202, v208 offset:0
    ds_write_b16 v202, v212 offset:64
    ds_write_b16 v202, v216 offset:128
    ds_write_b16 v202, v220 offset:192
    s_waitcnt lgkmcnt(0)
    s_barrier
    s_barrier
    s_endpgm
L_o03:
    s_mov_b32 s48, s24
    s_mov_b32 s49, s25
    s_mov_b32 s50, 4194304
    s_mov_b32 s51, 0x00020000
    v_lshrrev_b32 v3, 4, v0
    v_bfe_u32 v4, v0, 3, 1
    v_lshl_add_u32 v3, v4, 6, v3
    s_mov_b32 s3, 1024
    v_mul_lo_u32 v3, v3, s3
    v_and_b32 v4, 7, v0
    v_lshl_add_u32 v2, v4, 4, v3
    s_lshl_b32 s5, s66, 2
    s_add_u32 s76, s5, s44
    s_lshl_b32 s5, s76, 17
    s_lshl_b32 s6, s67, 7
    s_add_u32 s74, s5, s6
    buffer_load_dwordx4 v[64:67], v2, s[48:51], s74 offen nt
    s_add_u32 s74, s74, 8192
    buffer_load_dwordx4 v[68:71], v2, s[48:51], s74 offen nt
    s_add_u32 s74, s74, 8192
    buffer_load_dwordx4 v[72:75], v2, s[48:51], s74 offen nt
    s_add_u32 s74, s74, 8192
    buffer_load_dwordx4 v[76:79], v2, s[48:51], s74 offen nt
    s_add_u32 s74, s74, 8192
    buffer_load_dwordx4 v[80:83], v2, s[48:51], s74 offen nt
    s_add_u32 s74, s74, 8192
    buffer_load_dwordx4 v[84:87], v2, s[48:51], s74 offen nt
    s_add_u32 s74, s74, 8192
    buffer_load_dwordx4 v[88:91], v2, s[48:51], s74 offen nt
    s_add_u32 s74, s74, 8192
    buffer_load_dwordx4 v[92:95], v2, s[48:51], s74 offen nt
    s_sub_u32 s74, s74, 53248
    buffer_load_dwordx4 v[96:99], v2, s[48:51], s74 offen nt
    s_add_u32 s74, s74, 8192
    buffer_load_dwordx4 v[100:103], v2, s[48:51], s74 offen nt
    s_add_u32 s74, s74, 8192
    buffer_load_dwordx4 v[104:107], v2, s[48:51], s74 offen nt
    s_add_u32 s74, s74, 8192
    buffer_load_dwordx4 v[108:111], v2, s[48:51], s74 offen nt
    s_add_u32 s74, s74, 8192
    buffer_load_dwordx4 v[112:115], v2, s[48:51], s74 offen nt
    s_add_u32 s74, s74, 8192
    buffer_load_dwordx4 v[116:119], v2, s[48:51], s74 offen nt
    s_add_u32 s74, s74, 8192
    buffer_load_dwordx4 v[120:123], v2, s[48:51], s74 offen nt
    s_add_u32 s74, s74, 8192
    buffer_load_dwordx4 v[124:127], v2, s[48:51], s74 offen nt
    s_mul_i32 s5, s44, 768
    s_add_u32 s11, s5, 0
    v_and_b32 v6, 1, v0
    v_mul_u32_u24 v6, 384, v6
    v_bfe_u32 v3, v0, 1, 1
    v_lshl_add_u32 v6, v3, 4, v6
    v_lshrrev_b32 v3, 4, v0
    v_lshl_add_u32 v6, v3, 5, v6
    v_add_u32 v6, 0, v6
    v_add_u32 v6, s11, v6
    v_bfe_u32 v3, v0, 3, 1
    s_mov_b32 s3, 16384
    v_mul_lo_u32 v1, v3, s3
    v_and_b32 v3, 7, v0
    v_lshl_add_u32 v1, v3, 5, v1
    v_bfe_u32 v3, v0, 4, 1
    v_lshl_add_u32 v1, v3, 4, v1
    v_cmp_gt_u32 vcc, 32, v0
    v_mov_b32 v4, 1073741824
    s_nop 0
    v_cndmask_b32 v1, v4, v1, vcc
    v_mov_b32 v5, 0xffffff00
    s_lshl_b32 s5, s66, 11
    s_lshl_b32 s6, s67, 8
    s_add_u32 s77, s5, s6
    s_add_u32 s77, s77, 1048576
    v_lshlrev_b32 v7, 4, v0
    s_lshl_b32 s5, s44, 9
    s_add_u32 s5, s5, 4096
    v_add_u32 v19, s5, v7
    v_add_u32 v7, 4096, v7
    v_mov_b32 v60, v19
    s_lshr_b32 s3, s44, 1
    s_and_b32 s5, s44, 1
    s_lshl_b32 s4, s66, 2
    s_add_u32 s4, s4, s3
    s_lshl_b32 s6, s4, 1
    s_add_u32 s6, s6, s5
    s_lshl_b32 s6, s6, 12
    s_add_u32 s78, s6, 524288
    v_lshrrev_b32 v203, 3, v0
    v_and_b32 v204, 7, v0
    v_lshlrev_b32 v200, 9, v203
    v_lshl_add_u32 v200, v204, 4, v200
    s_lshl_b32 s4, s5, 7
    s_lshl_b32 s6, s3, 5
    s_add_u32 s4, s4, s6
    s_add_u32 s4, s4, 3840
    v_lshlrev_b32 v201, 2, v203
    v_add_u32 v201, s4, v201
    s_mul_i32 s5, s5, 384
    s_mul_i32 s3, s3, 768
    s_add_u32 s5, s5, s3
    s_add_u32 s5, s5, 0
    v_bfe_u32 v202, v0, 4, 1
    v_bfe_u32 v205, v0, 5, 1
    v_lshlrev_b32 v202, 2, v202
    v_lshl_add_u32 v202, v205, 1, v202
    v_lshl_add_u32 v202, v204, 3, v202
    v_add_u32 v202, s5, v202
    s_lshr_b32 s3, s44, 1
    s_and_b32 s5, s44, 1
    s_lshl_b32 s6, s66, 1
    s_add_u32 s6, s6, s5
    s_lshl_b32 s6, s6, 10
    s_lshl_b32 s3, s3, 4
    s_add_u32 s79, s6, s3
    s_add_u32 s79, s79, 262144
    s_add_u32 s12, s46, 1
    v_lshlrev_b32 v228, 7, v203
    s_mov_b32 s75, 1048576
    s_mov_b32 s76, 400
    s_add_u32 s79, s79, s75
    s_add_u32 s78, s78, s75
L_o03_h3_ml:
    s_cmp_eq_u32 s76, 0
    s_cbranch_scc0 L_o03_h3_go
    s_sub_u32 s79, s79, s75
    s_sub_u32 s78, s78, s75
    s_mov_b32 s75, 0
L_o03_h3_go:
    s_sub_u32 s76, s76, 1
    buffer_load_dwordx4 v[224:227], v228, s[52:55], s79 offen sc1
    s_waitcnt vmcnt(0)
    v_bitop3_b32 v229, v224, v225, s45 bitop3:0x7e
    v_and_b32 v229, 0xff, v229
    v_xor_b32 v226, s12, v226
    v_or_b32 v229, v229, v226
    v_cmp_ne_u32 vcc, 0, v229
    s_cbranch_vccz L_o03_h3_ml_ok
    s_sub_u32 s47, s47, 1
    s_cmp_gt_i32 s47, 0
    s_cbranch_scc1 L_o03_h3_ml
L_o03_h3_ml_ok:
    buffer_load_dwordx4 v[208:211], v200, s[52:55], s78 offen offset:0 sc1
    buffer_load_dwordx4 v[212:215], v200, s[52:55], s78 offen offset:128 sc1
    buffer_load_dwordx4 v[216:219], v200, s[52:55], s78 offen offset:256 sc1
    buffer_load_dwordx4 v[220:223], v200, s[52:55], s78 offen offset:384 sc1
    v_and_b32 v224, 0xffffff00, v224
    v_and_b32 v225, 0xffffff00, v225
    v_mov_b32 v230, v224
    s_nop 1
    v_max_f32_dpp v230, v230, v230 row_ror:8 row_mask:0xf bank_mask:0xf
    v_mov_b32 v231, v230
    s_nop 1
    v_permlane16_swap_b32 v230, v231
    v_max_f32 v230, v230, v231
    v_mov_b32 v231, v230
    s_nop 1
    v_permlane32_swap_b32 v230, v231
    v_max_f32 v230, v230, v231
    s_mov_b32 s3, 0x3fb8aa3b
    v_sub_f32 v224, v224, v230
    v_mul_f32 v224, s3, v224
    v_exp_f32 v224, v224
    s_nop 0
    v_mul_f32 v225, v224, v225
    s_nop 1
    v_add_f32_dpp v225, v225, v225 row_ror:8 row_mask:0xf bank_mask:0xf
    v_mov_b32 v231, v225
    s_nop 1
    v_permlane16_swap_b32 v225, v231
    v_add_f32 v225, v225, v231
    v_mov_b32 v231, v225
    s_nop 1
    v_permlane32_swap_b32 v225, v231
    v_add_f32 v225, v225, v231
    v_rcp_f32 v225, v225
    s_nop 0
    v_mul_f32 v206, v224, v225
    v_perm_b32 v128, v68, v64, s64
    v_perm_b32 v132, v68, v64, s65
    v_perm_b32 v136, v69, v65, s64
    v_perm_b32 v140, v69, v65, s65
    v_perm_b32 v144, v70, v66, s64
    v_perm_b32 v148, v70, v66, s65
    v_perm_b32 v152, v71, v67, s64
    v_perm_b32 v156, v71, v67, s65
    v_perm_b32 v129, v76, v72, s64
    v_perm_b32 v133, v76, v72, s65
    v_perm_b32 v137, v77, v73, s64
    v_perm_b32 v141, v77, v73, s65
    v_perm_b32 v145, v78, v74, s64
    v_perm_b32 v149, v78, v74, s65
    v_perm_b32 v153, v79, v75, s64
    v_perm_b32 v157, v79, v75, s65
    v_perm_b32 v130, v84, v80, s64
    v_perm_b32 v134, v84, v80, s65
    v_perm_b32 v138, v85, v81, s64
    v_perm_b32 v142, v85, v81, s65
    v_perm_b32 v146, v86, v82, s64
    v_perm_b32 v150, v86, v82, s65
    v_perm_b32 v154, v87, v83, s64
    v_perm_b32 v158, v87, v83, s65
    v_perm_b32 v131, v92, v88, s64
    v_perm_b32 v135, v92, v88, s65
    v_perm_b32 v139, v93, v89, s64
    v_perm_b32 v143, v93, v89, s65
    v_perm_b32 v147, v94, v90, s64
    v_perm_b32 v151, v94, v90, s65
    v_perm_b32 v155, v95, v91, s64
    v_perm_b32 v159, v95, v91, s65
    v_perm_b32 v160, v100, v96, s64
    v_perm_b32 v164, v100, v96, s65
    v_perm_b32 v168, v101, v97, s64
    v_perm_b32 v172, v101, v97, s65
    v_perm_b32 v176, v102, v98, s64
    v_perm_b32 v180, v102, v98, s65
    v_perm_b32 v184, v103, v99, s64
    v_perm_b32 v188, v103, v99, s65
    v_perm_b32 v161, v108, v104, s64
    v_perm_b32 v165, v108, v104, s65
    v_perm_b32 v169, v109, v105, s64
    v_perm_b32 v173, v109, v105, s65
    v_perm_b32 v177, v110, v106, s64
    v_perm_b32 v181, v110, v106, s65
    v_perm_b32 v185, v111, v107, s64
    v_perm_b32 v189, v111, v107, s65
    v_perm_b32 v162, v116, v112, s64
    v_perm_b32 v166, v116, v112, s65
    v_perm_b32 v170, v117, v113, s64
    v_perm_b32 v174, v117, v113, s65
    v_perm_b32 v178, v118, v114, s64
    v_perm_b32 v182, v118, v114, s65
    v_perm_b32 v186, v119, v115, s64
    v_perm_b32 v190, v119, v115, s65
    v_perm_b32 v163, v124, v120, s64
    v_perm_b32 v167, v124, v120, s65
    v_perm_b32 v171, v125, v121, s64
    v_perm_b32 v175, v125, v121, s65
    v_perm_b32 v179, v126, v122, s64
    v_perm_b32 v183, v126, v122, s65
    v_perm_b32 v187, v127, v123, s64
    v_perm_b32 v191, v127, v123, s65
    s_branch L_o03_h3_wait
L_o03_h3:
    buffer_load_dwordx4 v[208:211], v200, s[52:55], s78 offen offset:0 sc1
    buffer_load_dwordx4 v[212:215], v200, s[52:55], s78 offen offset:128 sc1
    buffer_load_dwordx4 v[216:219], v200, s[52:55], s78 offen offset:256 sc1
    buffer_load_dwordx4 v[220:223], v200, s[52:55], s78 offen offset:384 sc1
L_o03_h3_wait:
    s_waitcnt vmcnt(0)
    v_bitop3_b32 v224, v208, v209, s45 bitop3:0x7e
    v_bitop3_b32 v225, v210, v211, s45 bitop3:0x7e
    v_bitop3_b32 v226, v212, v213, s45 bitop3:0x7e
    v_bitop3_b32 v227, v214, v215, s45 bitop3:0x7e
    v_bitop3_b32 v228, v216, v217, s45 bitop3:0x7e
    v_bitop3_b32 v229, v218, v219, s45 bitop3:0x7e
    v_bitop3_b32 v230, v220, v221, s45 bitop3:0x7e
    v_bitop3_b32 v231, v222, v223, s45 bitop3:0x7e
    v_or3_b32 v224, v224, v225, v226
    v_or3_b32 v227, v227, v228, v229
    v_or_b32 v230, v230, v231
    v_or3_b32 v224, v224, v227, v230
    v_and_b32 v224, 0xff, v224
    v_cmp_ne_u32 vcc, 0, v224
    s_cbranch_vccz L_o03_h3_ok
    s_sub_u32 s47, s47, 1
    s_cmp_gt_i32 s47, 0
    s_cbranch_scc1 L_o03_h3
L_o03_h3_ok:
    v_and_b32 v208, 0xffffff00, v208
    v_and_b32 v209, 0xffffff00, v209
    v_and_b32 v210, 0xffffff00, v210
    v_and_b32 v211, 0xffffff00, v211
    v_and_b32 v212, 0xffffff00, v212
    v_and_b32 v213, 0xffffff00, v213
    v_and_b32 v214, 0xffffff00, v214
    v_and_b32 v215, 0xffffff00, v215
    v_and_b32 v216, 0xffffff00, v216
    v_and_b32 v217, 0xffffff00, v217
    v_and_b32 v218, 0xffffff00, v218
    v_and_b32 v219, 0xffffff00, v219
    v_and_b32 v220, 0xffffff00, v220
    v_and_b32 v221, 0xffffff00, v221
    v_and_b32 v222, 0xffffff00, v222
    v_and_b32 v223, 0xffffff00, v223
    v_pk_mul_f32 v[208:209], v[208:209], v[206:207] op_sel_hi:[1,0]
    v_pk_mul_f32 v[210:211], v[210:211], v[206:207] op_sel_hi:[1,0]
    v_pk_mul_f32 v[212:213], v[212:213], v[206:207] op_sel_hi:[1,0]
    v_pk_mul_f32 v[214:215], v[214:215], v[206:207] op_sel_hi:[1,0]
    v_pk_mul_f32 v[216:217], v[216:217], v[206:207] op_sel_hi:[1,0]
    v_pk_mul_f32 v[218:219], v[218:219], v[206:207] op_sel_hi:[1,0]
    v_pk_mul_f32 v[220:221], v[220:221], v[206:207] op_sel_hi:[1,0]
    v_pk_mul_f32 v[222:223], v[222:223], v[206:207] op_sel_hi:[1,0]
    v_permlane32_swap_b32 v208, v209
    v_permlane32_swap_b32 v210, v211
    v_permlane32_swap_b32 v212, v213
    v_permlane32_swap_b32 v214, v215
    v_permlane32_swap_b32 v216, v217
    v_permlane32_swap_b32 v218, v219
    v_permlane32_swap_b32 v220, v221
    v_permlane32_swap_b32 v222, v223
    v_add_f32 v208, v208, v209
    v_add_f32 v210, v210, v211
    v_add_f32 v212, v212, v213
    v_add_f32 v214, v214, v215
    v_add_f32 v216, v216, v217
    v_add_f32 v218, v218, v219
    v_add_f32 v220, v220, v221
    v_add_f32 v222, v222, v223
    v_permlane16_swap_b32 v208, v210
    v_permlane16_swap_b32 v212, v214
    v_permlane16_swap_b32 v216, v218
    v_permlane16_swap_b32 v220, v222
    v_add_f32 v208, v208, v210
    v_add_f32 v212, v212, v214
    v_add_f32 v216, v216, v218
    v_add_f32 v220, v220, v222
    v_add_f32_dpp v208, v208, v208 row_ror:8 row_mask:0xf bank_mask:0xf
    v_add_f32_dpp v212, v212, v212 row_ror:8 row_mask:0xf bank_mask:0xf
    v_add_f32_dpp v216, v216, v216 row_ror:8 row_mask:0xf bank_mask:0xf
    v_add_f32_dpp v220, v220, v220 row_ror:8 row_mask:0xf bank_mask:0xf
    v_cvt_pk_bf16_f32 v208, v208, v208
    v_cvt_pk_bf16_f32 v212, v212, v212
    v_cvt_pk_bf16_f32 v216, v216, v216
    v_cvt_pk_bf16_f32 v220, v220, v220
    ds_write_b16 v202, v208 offset:0
    ds_write_b16 v202, v212 offset:64
    ds_write_b16 v202, v216 offset:128
    ds_write_b16 v202, v220 offset:192
    s_waitcnt lgkmcnt(0)
    s_barrier
    ds_read_b128 v[16:19], v6
    ds_read_b128 v[20:23], v6 offset:128
    s_waitcnt lgkmcnt(0)
    v_mfma_f32_16x16x32_bf16 v[24:27], v[16:19], v[128:131], 0
    v_mfma_f32_16x16x32_bf16 v[28:31], v[16:19], v[132:135], 0
    v_mfma_f32_16x16x32_bf16 v[32:35], v[16:19], v[136:139], 0
    v_mfma_f32_16x16x32_bf16 v[36:39], v[16:19], v[140:143], 0
    v_mfma_f32_16x16x32_bf16 v[40:43], v[16:19], v[144:147], 0
    v_mfma_f32_16x16x32_bf16 v[44:47], v[16:19], v[148:151], 0
    v_mfma_f32_16x16x32_bf16 v[48:51], v[16:19], v[152:155], 0
    v_mfma_f32_16x16x32_bf16 v[52:55], v[16:19], v[156:159], 0
    v_mfma_f32_16x16x32_bf16 v[24:27], v[20:23], v[160:163], v[24:27]
    v_mfma_f32_16x16x32_bf16 v[28:31], v[20:23], v[164:167], v[28:31]
    v_mfma_f32_16x16x32_bf16 v[32:35], v[20:23], v[168:171], v[32:35]
    v_mfma_f32_16x16x32_bf16 v[36:39], v[20:23], v[172:175], v[36:39]
    v_mfma_f32_16x16x32_bf16 v[40:43], v[20:23], v[176:179], v[40:43]
    v_mfma_f32_16x16x32_bf16 v[44:47], v[20:23], v[180:183], v[44:47]
    v_mfma_f32_16x16x32_bf16 v[48:51], v[20:23], v[184:187], v[48:51]
    v_mfma_f32_16x16x32_bf16 v[52:55], v[20:23], v[188:191], v[52:55]
    s_nop 0
    v_add_f32_dpp v56, v26, v24 row_ror:8 row_mask:0x1 bank_mask:0x3
    v_add_f32_dpp v56, v25, v27 row_ror:8 row_mask:0x1 bank_mask:0xc
    v_add_f32_dpp v57, v30, v28 row_ror:8 row_mask:0x1 bank_mask:0x3
    v_add_f32_dpp v57, v29, v31 row_ror:8 row_mask:0x1 bank_mask:0xc
    v_add_f32_dpp v58, v34, v32 row_ror:8 row_mask:0x1 bank_mask:0x3
    v_add_f32_dpp v58, v33, v35 row_ror:8 row_mask:0x1 bank_mask:0xc
    v_add_f32_dpp v59, v38, v36 row_ror:8 row_mask:0x1 bank_mask:0x3
    v_add_f32_dpp v59, v37, v39 row_ror:8 row_mask:0x1 bank_mask:0xc
    v_add_f32_dpp v56, v42, v40 row_ror:8 row_mask:0x2 bank_mask:0x3
    v_add_f32_dpp v56, v41, v43 row_ror:8 row_mask:0x2 bank_mask:0xc
    v_add_f32_dpp v57, v46, v44 row_ror:8 row_mask:0x2 bank_mask:0x3
    v_add_f32_dpp v57, v45, v47 row_ror:8 row_mask:0x2 bank_mask:0xc
    v_add_f32_dpp v58, v50, v48 row_ror:8 row_mask:0x2 bank_mask:0x3
    v_add_f32_dpp v58, v49, v51 row_ror:8 row_mask:0x2 bank_mask:0xc
    v_add_f32_dpp v59, v54, v52 row_ror:8 row_mask:0x2 bank_mask:0x3
    v_add_f32_dpp v59, v53, v55 row_ror:8 row_mask:0x2 bank_mask:0xc
    s_mov_b32 exec_hi, 0
    ds_write_b128 v60, v[56:59]
    s_mov_b64 exec, -1
    s_waitcnt lgkmcnt(0)
    s_barrier
    s_cmp_eq_u32 s44, 0
    s_cbranch_scc0 L_o_end
    ds_read_b128 v[24:27], v7 offset:0
    ds_read_b128 v[28:31], v7 offset:512
    ds_read_b128 v[32:35], v7 offset:1024
    ds_read_b128 v[36:39], v7 offset:1536
    s_waitcnt lgkmcnt(0)
    v_pk_add_f32 v[24:25], v[24:25], v[28:29]
    v_pk_add_f32 v[26:27], v[26:27], v[30:31]
    v_pk_add_f32 v[32:33], v[32:33], v[36:37]
    v_pk_add_f32 v[34:35], v[34:35], v[38:39]
    v_pk_add_f32 v[24:25], v[24:25], v[32:33]
    v_pk_add_f32 v[26:27], v[26:27], v[34:35]
    v_bfi_b32 v24, v5, v24, s45
    v_bfi_b32 v25, v5, v25, s45
    v_bfi_b32 v26, v5, v26, s45
    v_bfi_b32 v27, v5, v27, s45
    buffer_store_dwordx4 v[24:27], v1, s[52:55], s77 offen sc1
L_o_end:
    s_endpgm
L_ftype:
    s_mul_i32 s14, s66, 7
    s_add_u32 s14, s14, s67
    s_sub_u32 s14, s14, 8
    s_cmp_lt_u32 s44, 4
    s_cbranch_scc0 L_f47
    s_lshr_b32 s15, s44, 1
    s_and_b32 s8, s44, 1
    s_cmp_eq_u32 s15, 0
    s_cselect_b32 s48, s28, s30
    s_cselect_b32 s49, s29, s31
    s_mov_b32 s50, 1835008
    s_mov_b32 s51, 0x00020000
    v_lshrrev_b32 v3, 4, v0
    v_bfe_u32 v4, v0, 2, 2
    v_lshlrev_b32 v3, 5, v3
    v_lshl_add_u32 v3, v4, 3, v3
    s_mov_b32 s3, 3584
    v_mul_lo_u32 v3, v3, s3
    v_and_b32 v4, 3, v0
    v_lshl_add_u32 v2, v4, 4, v3
    s_mul_i32 s5, s8, 917504
    s_lshl_b32 s6, s14, 6
    s_add_u32 s74, s5, s6
    buffer_load_dwordx4 v[64:67], v2, s[48:51], s74 offen nt
    s_add_u32 s74, s74, 3584
    buffer_load_dwordx4 v[68:71], v2, s[48:51], s74 offen nt
    s_add_u32 s74, s74, 3584
    buffer_load_dwordx4 v[72:75], v2, s[48:51], s74 offen nt
    s_add_u32 s74, s74, 3584
    buffer_load_dwordx4 v[76:79], v2, s[48:51], s74 offen nt
    s_add_u32 s74, s74, 3584
    buffer_load_dwordx4 v[80:83], v2, s[48:51], s74 offen nt
    s_add_u32 s74, s74, 3584
    buffer_load_dwordx4 v[84:87], v2, s[48:51], s74 offen nt
    s_add_u32 s74, s74, 3584
    buffer_load_dwordx4 v[88:91], v2, s[48:51], s74 offen nt
    s_add_u32 s74, s74, 3584
    buffer_load_dwordx4 v[92:95], v2, s[48:51], s74 offen nt
    s_add_u32 s74, s74, 433664
    buffer_load_dwordx4 v[96:99], v2, s[48:51], s74 offen nt
    s_add_u32 s74, s74, 3584
    buffer_load_dwordx4 v[100:103], v2, s[48:51], s74 offen nt
    s_add_u32 s74, s74, 3584
    buffer_load_dwordx4 v[104:107], v2, s[48:51], s74 offen nt
    s_add_u32 s74, s74, 3584
    buffer_load_dwordx4 v[108:111], v2, s[48:51], s74 offen nt
    s_add_u32 s74, s74, 3584
    buffer_load_dwordx4 v[112:115], v2, s[48:51], s74 offen nt
    s_add_u32 s74, s74, 3584
    buffer_load_dwordx4 v[116:119], v2, s[48:51], s74 offen nt
    s_add_u32 s74, s74, 3584
    buffer_load_dwordx4 v[120:123], v2, s[48:51], s74 offen nt
    s_add_u32 s74, s74, 3584
    buffer_load_dwordx4 v[124:127], v2, s[48:51], s74 offen nt
    v_bfe_u32 v6, v0, 2, 1
    v_mul_u32_u24 v6, 1152, v6
    v_lshrrev_b32 v3, 4, v0
    v_lshl_add_u32 v6, v3, 6, v6
    v_and_b32 v3, 3, v0
    v_lshl_add_u32 v6, v3, 4, v6
    s_lshl_b32 s5, s8, 9
    s_add_u32 s5, s5, 10304
    v_add_u32 v6, s5, v6
    v_bfe_u32 v7, v0, 4, 1
    v_lshlrev_b32 v7, 7, v7
    v_and_b32 v3, 3, v0
    v_lshl_add_u32 v7, v3, 5, v7
    v_bfe_u32 v3, v0, 2, 2
    v_lshl_add_u32 v7, v3, 3, v7
    s_lshl_b32 s5, s44, 8
    s_add_u32 s5, s5, 12608
    v_add_u32 v7, s5, v7
    v_mov_b32 v5, 0xffffff00
    s_lshr_b32 s9, s44, 2
    s_and_b32 s10, s44, 3
    v_and_b32 v61, 31, v0
    v_lshrrev_b32 v62, 5, v0
    v_bfe_u32 v3, v0, 4, 1
    v_lshlrev_b32 v63, 11, v3
    v_lshl_add_u32 v63, v62, 9, v63
    v_and_b32 v3, 15, v0
    v_lshl_add_u32 v63, v3, 4, v63
    s_lshl_b32 s5, s10, 12
    s_lshl_b32 s6, s9, 8
    s_add_u32 s5, s5, s6
    s_add_u32 s11, s5, 36864
    s_add_u32 s12, s5, 53248
    s_add_u32 s13, s5, 69632
    s_mov_b32 s56, s16
    s_mov_b32 s57, s17
    s_mov_b32 s58, 2048
    s_mov_b32 s59, 0x00020000
    s_lshl_b32 s5, s9, 10
    s_lshl_b32 s6, s10, 8
    s_add_u32 s5, s5, s6
    v_lshlrev_b32 v3, 3, v61
    buffer_load_dwordx2 v[216:217], v3, s[56:59], s5 offen
L_f_moda:
    buffer_load_dwordx4 v[192:195], v63, s[52:55], s11 offen offset:0 sc1
    buffer_load_dwordx4 v[196:199], v63, s[52:55], s11 offen offset:1024 sc1
    buffer_load_dwordx4 v[200:203], v63, s[52:55], s12 offen offset:0 sc1
    buffer_load_dwordx4 v[204:207], v63, s[52:55], s12 offen offset:1024 sc1
    buffer_load_dwordx4 v[208:211], v63, s[52:55], s13 offen offset:0 sc1
    buffer_load_dwordx4 v[212:215], v63, s[52:55], s13 offen offset:1024 sc1
    s_waitcnt vmcnt(0)
    v_bitop3_b32 v224, v192, v193, s45 bitop3:0x7e
    v_bitop3_b32 v225, v194, v195, s45 bitop3:0x7e
    v_bitop3_b32 v226, v196, v197, s45 bitop3:0x7e
    v_bitop3_b32 v227, v198, v199, s45 bitop3:0x7e
    v_bitop3_b32 v228, v200, v201, s45 bitop3:0x7e
    v_bitop3_b32 v229, v202, v203, s45 bitop3:0x7e
    v_bitop3_b32 v230, v204, v205, s45 bitop3:0x7e
    v_bitop3_b32 v231, v206, v207, s45 bitop3:0x7e
    v_bitop3_b32 v232, v208, v209, s45 bitop3:0x7e
    v_bitop3_b32 v233, v210, v211, s45 bitop3:0x7e
    v_bitop3_b32 v234, v212, v213, s45 bitop3:0x7e
    v_bitop3_b32 v235, v214, v215, s45 bitop3:0x7e
    v_or3_b32 v224, v224, v225, v226
    v_or3_b32 v227, v227, v228, v229
    v_or3_b32 v230, v230, v231, v232
    v_or3_b32 v233, v233, v234, v235
    v_or3_b32 v224, v224, v227, v230
    v_or_b32 v224, v224, v233
    v_and_b32 v224, 0xff, v224
    v_cmp_ne_u32 vcc, 0, v224
    s_cbranch_vccz L_f_moda_ok
    s_sleep 8
    s_sub_u32 s47, s47, 1
    s_cmp_gt_i32 s47, 0
    s_cbranch_scc1 L_f_moda
L_f_moda_ok:
    v_and_b32 v192, 0xffffff00, v192
    v_and_b32 v193, 0xffffff00, v193
    v_and_b32 v194, 0xffffff00, v194
    v_and_b32 v195, 0xffffff00, v195
    v_and_b32 v196, 0xffffff00, v196
    v_and_b32 v197, 0xffffff00, v197
    v_and_b32 v198, 0xffffff00, v198
    v_and_b32 v199, 0xffffff00, v199
    v_and_b32 v200, 0xffffff00, v200
    v_and_b32 v201, 0xffffff00, v201
    v_and_b32 v202, 0xffffff00, v202
    v_and_b32 v203, 0xffffff00, v203
    v_and_b32 v204, 0xffffff00, v204
    v_and_b32 v205, 0xffffff00, v205
    v_and_b32 v206, 0xffffff00, v206
    v_and_b32 v207, 0xffffff00, v207
    v_and_b32 v208, 0xffffff00, v208
    v_and_b32 v209, 0xffffff00, v209
    v_and_b32 v210, 0xffffff00, v210
    v_and_b32 v211, 0xffffff00, v211
    v_and_b32 v212, 0xffffff00, v212
    v_and_b32 v213, 0xffffff00, v213
    v_and_b32 v214, 0xffffff00, v214
    v_and_b32 v215, 0xffffff00, v215
    v_add_f32 v192, v192, v196
    v_add_f32 v193, v193, v197
    v_add_f32 v194, v194, v198
    v_add_f32 v195, v195, v199
    v_add_f32 v200, v200, v204
    v_add_f32 v201, v201, v205
    v_add_f32 v202, v202, v206
    v_add_f32 v203, v203, v207
    v_add_f32 v208, v208, v212
    v_add_f32 v209, v209, v213
    v_add_f32 v210, v210, v214
    v_add_f32 v211, v211, v215
    v_permlane32_swap_b32 v192, v193
    v_permlane32_swap_b32 v194, v195
    v_permlane32_swap_b32 v200, v201
    v_permlane32_swap_b32 v202, v203
    v_permlane32_swap_b32 v208, v209
    v_permlane32_swap_b32 v210, v211
    v_add_f32 v192, v192, v193
    v_add_f32 v193, v194, v195
    v_add_f32 v200, v200, v201
    v_add_f32 v201, v202, v203
    v_add_f32 v208, v208, v209
    v_add_f32 v209, v210, v211
    v_cvt_pk_bf16_f32 v224, v192, v193
    v_cvt_pk_bf16_f32 v225, v200, v201
    v_cvt_pk_bf16_f32 v226, v208, v209
    v_lshlrev_b32 v192, 16, v224
    v_and_b32 v193, 0xffff0000, v224
    v_lshlrev_b32 v200, 16, v225
    v_and_b32 v201, 0xffff0000, v225
    v_lshlrev_b32 v208, 16, v226
    v_and_b32 v209, 0xffff0000, v226
    v_add_f32 v208, 1.0, v208
    v_add_f32 v209, 1.0, v209
    v_cvt_pk_bf16_f32 v224, v208, v209
    v_lshlrev_b32 v208, 16, v224
    v_and_b32 v209, 0xffff0000, v224
    v_cmp_gt_u32 vcc, 32, v0
    v_lshlrev_b32 v194, 16, v216
    v_and_b32 v195, 0xffff0000, v216
    v_lshlrev_b32 v196, 16, v217
    v_and_b32 v197, 0xffff0000, v217
    v_cndmask_b32 v194, v195, v194, vcc
    v_cndmask_b32 v195, v197, v196, vcc
    v_lshl_add_u32 v3, v61, 2, v62
    s_lshl_b32 s5, s10, 7
    v_add_u32 v3, s5, v3
    s_lshl_b32 s5, s9, 11
    s_add_u32 s5, s5, 6144
    v_lshl_add_u32 v198, v3, 2, s5
    s_mul_i32 s5, s9, 1152
    s_add_u32 s5, s5, 10304
    v_lshl_add_u32 v199, v3, 1, s5
    s_lshl_b32 s5, s44, 3
    s_add_u32 s5, s5, 10240
    v_lshl_add_u32 v202, v62, 2, s5
    s_lshl_b32 s5, s9, 5
    s_add_u32 s5, s5, 10240
    v_mov_b32 v203, s5
    s_cmp_eq_u32 s44, 0
    s_cbranch_scc0 L_f_nogba
    s_cmp_lt_u32 s14, 32
    s_cbranch_scc0 L_f_nogba
    s_lshr_b32 s5, s14, 4
    s_and_b32 s6, s14, 15
    s_lshr_b32 s3, s6, 1
    s_add_u32 s3, s3, 40
    s_lshl_b32 s3, s3, 11
    s_lshl_b32 s4, s5, 8
    s_add_u32 s3, s3, s4
    s_and_b32 s4, s6, 1
    s_lshl_b32 s4, s4, 7
    s_add_u32 s3, s3, s4
    s_add_u32 s75, s3, 4096
    v_and_b32 v3, 15, v0
    v_lshlrev_b32 v3, 1, v3
    v_add_u32 v3, v3, v62
    v_lshlrev_b32 v4, 2, v3
L_f_gba:
    buffer_load_dword v218, v4, s[52:55], s75 offen offset:0 sc1
    buffer_load_dword v219, v4, s[52:55], s75 offen offset:512 sc1
    buffer_load_dword v220, v4, s[52:55], s75 offen offset:1024 sc1
    buffer_load_dword v221, v4, s[52:55], s75 offen offset:1536 sc1
    s_waitcnt vmcnt(0)
    v_bitop3_b32 v224, v218, v219, s45 bitop3:0x7e
    v_bitop3_b32 v225, v220, v221, s45 bitop3:0x7e
    v_or_b32 v224, v224, v225
    v_and_b32 v224, 0xff, v224
    v_cmp_ne_u32 vcc, 0, v224
    s_cbranch_vccz L_f_gba_ok
    s_sub_u32 s47, s47, 1
    s_cmp_gt_i32 s47, 0
    s_cbranch_scc1 L_f_gba
L_f_gba_ok:
    v_and_b32 v218, 0xffffff00, v218
    v_and_b32 v219, 0xffffff00, v219
    v_and_b32 v220, 0xffffff00, v220
    v_and_b32 v221, 0xffffff00, v221
    v_add_f32 v218, v218, v219
    v_add_f32 v220, v220, v221
    v_add_f32 v204, v218, v220
    v_cvt_pk_bf16_f32 v224, v204, v204
    v_lshlrev_b32 v204, 16, v224
    v_mov_b32 v205, v3
L_f_nogba:
    s_waitcnt vmcnt(14)
    v_perm_b32 v128, v68, v64, s64
    v_perm_b32 v132, v68, v64, s65
    v_perm_b32 v136, v69, v65, s64
    v_perm_b32 v140, v69, v65, s65
    v_perm_b32 v144, v70, v66, s64
    v_perm_b32 v148, v70, v66, s65
    v_perm_b32 v152, v71, v67, s64
    v_perm_b32 v156, v71, v67, s65
    s_waitcnt vmcnt(12)
    v_perm_b32 v129, v76, v72, s64
    v_perm_b32 v133, v76, v72, s65
    v_perm_b32 v137, v77, v73, s64
    v_perm_b32 v141, v77, v73, s65
    v_perm_b32 v145, v78, v74, s64
    v_perm_b32 v149, v78, v74, s65
    v_perm_b32 v153, v79, v75, s64
    v_perm_b32 v157, v79, v75, s65
    s_waitcnt vmcnt(10)
    v_perm_b32 v130, v84, v80, s64
    v_perm_b32 v134, v84, v80, s65
    v_perm_b32 v138, v85, v81, s64
    v_perm_b32 v142, v85, v81, s65
    v_perm_b32 v146, v86, v82, s64
    v_perm_b32 v150, v86, v82, s65
    v_perm_b32 v154, v87, v83, s64
    v_perm_b32 v158, v87, v83, s65
    s_waitcnt vmcnt(8)
    v_perm_b32 v131, v92, v88, s64
    v_perm_b32 v135, v92, v88, s65
    v_perm_b32 v139, v93, v89, s64
    v_perm_b32 v143, v93, v89, s65
    v_perm_b32 v147, v94, v90, s64
    v_perm_b32 v151, v94, v90, s65
    v_perm_b32 v155, v95, v91, s64
    v_perm_b32 v159, v95, v91, s65
    s_waitcnt vmcnt(6)
    v_perm_b32 v160, v100, v96, s64
    v_perm_b32 v164, v100, v96, s65
    v_perm_b32 v168, v101, v97, s64
    v_perm_b32 v172, v101, v97, s65
    v_perm_b32 v176, v102, v98, s64
    v_perm_b32 v180, v102, v98, s65
    v_perm_b32 v184, v103, v99, s64
    v_perm_b32 v188, v103, v99, s65
    s_waitcnt vmcnt(4)
    v_perm_b32 v161, v108, v104, s64
    v_perm_b32 v165, v108, v104, s65
    v_perm_b32 v169, v109, v105, s64
    v_perm_b32 v173, v109, v105, s65
    v_perm_b32 v177, v110, v106, s64
    v_perm_b32 v181, v110, v106, s65
    v_perm_b32 v185, v111, v107, s64
    v_perm_b32 v189, v111, v107, s65
    s_waitcnt vmcnt(2)
    v_perm_b32 v162, v116, v112, s64
    v_perm_b32 v166, v116, v112, s65
    v_perm_b32 v170, v117, v113, s64
    v_perm_b32 v174, v117, v113, s65
    v_perm_b32 v178, v118, v114, s64
    v_perm_b32 v182, v118, v114, s65
    v_perm_b32 v186, v119, v115, s64
    v_perm_b32 v190, v119, v115, s65
    s_waitcnt vmcnt(0)
    v_perm_b32 v163, v124, v120, s64
    v_perm_b32 v167, v124, v120, s65
    v_perm_b32 v171, v125, v121, s64
    v_perm_b32 v175, v125, v121, s65
    v_perm_b32 v179, v126, v122, s64
    v_perm_b32 v183, v126, v122, s65
    v_perm_b32 v187, v127, v123, s64
    v_perm_b32 v191, v127, v123, s65
    s_branch L_f_x
L_f47:
    s_mov_b32 s48, s32
    s_mov_b32 s49, s33
    s_mov_b32 s50, 1835008
    s_mov_b32 s51, 0x00020000
    s_sub_u32 s15, s44, 4
    v_lshrrev_b32 v3, 4, v0
    v_lshlrev_b32 v3, 13, v3
    v_and_b32 v4, 15, v0
    v_lshl_add_u32 v2, v4, 4, v3
    s_lshl_b32 s5, s14, 15
    s_lshl_b32 s6, s15, 8
    s_add_u32 s74, s5, s6
    buffer_load_dwordx4 v[64:67], v2, s[48:51], s74 offen nt
    s_add_u32 s74, s74, 1024
    buffer_load_dwordx4 v[68:71], v2, s[48:51], s74 offen nt
    s_add_u32 s74, s74, 1024
    buffer_load_dwordx4 v[72:75], v2, s[48:51], s74 offen nt
    s_add_u32 s74, s74, 1024
    buffer_load_dwordx4 v[76:79], v2, s[48:51], s74 offen nt
    s_add_u32 s74, s74, 1024
    buffer_load_dwordx4 v[80:83], v2, s[48:51], s74 offen nt
    s_add_u32 s74, s74, 1024
    buffer_load_dwordx4 v[84:87], v2, s[48:51], s74 offen nt
    s_add_u32 s74, s74, 1024
    buffer_load_dwordx4 v[88:91], v2, s[48:51], s74 offen nt
    s_add_u32 s74, s74, 1024
    buffer_load_dwordx4 v[92:95], v2, s[48:51], s74 offen nt
    v_lshrrev_b32 v7, 5, v0
    v_lshlrev_b32 v7, 7, v7
    v_bfe_u32 v3, v0, 3, 2
    v_lshl_add_u32 v7, v3, 5, v7
    v_and_b32 v3, 3, v0
    v_lshl_add_u32 v7, v3, 3, v7
    v_bfe_u32 v3, v0, 2, 1
    v_lshl_add_u32 v7, v3, 2, v7
    v_add_u32 v7, 12608, v7
    s_lshl_b32 s5, s15, 8
    s_add_u32 s5, s5, 13632
    v_lshrrev_b32 v60, 5, v0
    v_lshlrev_b32 v60, 7, v60
    v_and_b32 v3, 31, v0
    v_lshl_add_u32 v60, v3, 1, v60
    v_add_u32 v60, s5, v60
    v_and_b32 v6, 1, v0
    v_lshlrev_b32 v6, 7, v6
    v_lshrrev_b32 v3, 4, v0
    v_lshl_add_u32 v6, v3, 4, v6
    v_add_u32 v6, s5, v6
    v_lshrrev_b32 v3, 5, v0
    v_lshlrev_b32 v3, 4, v3
    v_bfe_u32 v4, v0, 2, 2
    v_add_u32 v3, v3, v4
    s_lshl_b32 s5, s15, 2
    v_add_u32 v3, s5, v3
    v_mul_u32_u24 v1, 7168, v3
    v_and_b32 v3, 3, v0
    v_lshl_add_u32 v1, v3, 5, v1
    v_bfe_u32 v3, v0, 4, 1
    v_lshl_add_u32 v1, v3, 4, v1
    s_lshl_b32 s5, s14, 7
    s_add_u32 s77, s5, 2359296
    v_mov_b32 v5, 0xffffff00
    s_lshr_b32 s9, s44, 2
    s_and_b32 s10, s44, 3
    v_and_b32 v61, 31, v0
    v_lshrrev_b32 v62, 5, v0
    v_bfe_u32 v3, v0, 4, 1
    v_lshlrev_b32 v63, 11, v3
    v_lshl_add_u32 v63, v62, 9, v63
    v_and_b32 v3, 15, v0
    v_lshl_add_u32 v63, v3, 4, v63
    s_lshl_b32 s5, s10, 12
    s_lshl_b32 s6, s9, 8
    s_add_u32 s5, s5, s6
    s_add_u32 s11, s5, 36864
    s_add_u32 s12, s5, 53248
    s_add_u32 s13, s5, 69632
    s_mov_b32 s56, s16
    s_mov_b32 s57, s17
    s_mov_b32 s58, 2048
    s_mov_b32 s59, 0x00020000
    s_lshl_b32 s5, s9, 10
    s_lshl_b32 s6, s10, 8
    s_add_u32 s5, s5, s6
    v_lshlrev_b32 v3, 3, v61
    buffer_load_dwordx2 v[216:217], v3, s[56:59], s5 offen
L_f_modb:
    buffer_load_dwordx4 v[192:195], v63, s[52:55], s11 offen offset:0 sc1
    buffer_load_dwordx4 v[196:199], v63, s[52:55], s11 offen offset:1024 sc1
    buffer_load_dwordx4 v[200:203], v63, s[52:55], s12 offen offset:0 sc1
    buffer_load_dwordx4 v[204:207], v63, s[52:55], s12 offen offset:1024 sc1
    buffer_load_dwordx4 v[208:211], v63, s[52:55], s13 offen offset:0 sc1
    buffer_load_dwordx4 v[212:215], v63, s[52:55], s13 offen offset:1024 sc1
    s_waitcnt vmcnt(0)
    v_bitop3_b32 v224, v192, v193, s45 bitop3:0x7e
    v_bitop3_b32 v225, v194, v195, s45 bitop3:0x7e
    v_bitop3_b32 v226, v196, v197, s45 bitop3:0x7e
    v_bitop3_b32 v227, v198, v199, s45 bitop3:0x7e
    v_bitop3_b32 v228, v200, v201, s45 bitop3:0x7e
    v_bitop3_b32 v229, v202, v203, s45 bitop3:0x7e
    v_bitop3_b32 v230, v204, v205, s45 bitop3:0x7e
    v_bitop3_b32 v231, v206, v207, s45 bitop3:0x7e
    v_bitop3_b32 v232, v208, v209, s45 bitop3:0x7e
    v_bitop3_b32 v233, v210, v211, s45 bitop3:0x7e
    v_bitop3_b32 v234, v212, v213, s45 bitop3:0x7e
    v_bitop3_b32 v235, v214, v215, s45 bitop3:0x7e
    v_or3_b32 v224, v224, v225, v226
    v_or3_b32 v227, v227, v228, v229
    v_or3_b32 v230, v230, v231, v232
    v_or3_b32 v233, v233, v234, v235
    v_or3_b32 v224, v224, v227, v230
    v_or_b32 v224, v224, v233
    v_and_b32 v224, 0xff, v224
    v_cmp_ne_u32 vcc, 0, v224
    s_cbranch_vccz L_f_modb_ok
    s_sleep 8
    s_sub_u32 s47, s47, 1
    s_cmp_gt_i32 s47, 0
    s_cbranch_scc1 L_f_modb
L_f_modb_ok:
    v_and_b32 v192, 0xffffff00, v192
    v_and_b32 v193, 0xffffff00, v193
    v_and_b32 v194, 0xffffff00, v194
    v_and_b32 v195, 0xffffff00, v195
    v_and_b32 v196, 0xffffff00, v196
    v_and_b32 v197, 0xffffff00, v197
    v_and_b32 v198, 0xffffff00, v198
    v_and_b32 v199, 0xffffff00, v199
    v_and_b32 v200, 0xffffff00, v200
    v_and_b32 v201, 0xffffff00, v201
    v_and_b32 v202, 0xffffff00, v202
    v_and_b32 v203, 0xffffff00, v203
    v_and_b32 v204, 0xffffff00, v204
    v_and_b32 v205, 0xffffff00, v205
    v_and_b32 v206, 0xffffff00, v206
    v_and_b32 v207, 0xffffff00, v207
    v_and_b32 v208, 0xffffff00, v208
    v_and_b32 v209, 0xffffff00, v209
    v_and_b32 v210, 0xffffff00, v210
    v_and_b32 v211, 0xffffff00, v211
    v_and_b32 v212, 0xffffff00, v212
    v_and_b32 v213, 0xffffff00, v213
    v_and_b32 v214, 0xffffff00, v214
    v_and_b32 v215, 0xffffff00, v215
    v_add_f32 v192, v192, v196
    v_add_f32 v193, v193, v197
    v_add_f32 v194, v194, v198
    v_add_f32 v195, v195, v199
    v_add_f32 v200, v200, v204
    v_add_f32 v201, v201, v205
    v_add_f32 v202, v202, v206
    v_add_f32 v203, v203, v207
    v_add_f32 v208, v208, v212
    v_add_f32 v209, v209, v213
    v_add_f32 v210, v210, v214
    v_add_f32 v211, v211, v215
    v_permlane32_swap_b32 v192, v193
    v_permlane32_swap_b32 v194, v195
    v_permlane32_swap_b32 v200, v201
    v_permlane32_swap_b32 v202, v203
    v_permlane32_swap_b32 v208, v209
    v_permlane32_swap_b32 v210, v211
    v_add_f32 v192, v192, v193
    v_add_f32 v193, v194, v195
    v_add_f32 v200, v200, v201
    v_add_f32 v201, v202, v203
    v_add_f32 v208, v208, v209
    v_add_f32 v209, v210, v211
    v_cvt_pk_bf16_f32 v224, v192, v193
    v_cvt_pk_bf16_f32 v225, v200, v201
    v_cvt_pk_bf16_f32 v226, v208, v209
    v_lshlrev_b32 v192, 16, v224
    v_and_b32 v193, 0xffff0000, v224
    v_lshlrev_b32 v200, 16, v225
    v_and_b32 v201, 0xffff0000, v225
    v_lshlrev_b32 v208, 16, v226
    v_and_b32 v209, 0xffff0000, v226
    v_add_f32 v208, 1.0, v208
    v_add_f32 v209, 1.0, v209
    v_cvt_pk_bf16_f32 v224, v208, v209
    v_lshlrev_b32 v208, 16, v224
    v_and_b32 v209, 0xffff0000, v224
    v_cmp_gt_u32 vcc, 32, v0
    v_lshlrev_b32 v194, 16, v216
    v_and_b32 v195, 0xffff0000, v216
    v_lshlrev_b32 v196, 16, v217
    v_and_b32 v197, 0xffff0000, v217
    v_cndmask_b32 v194, v195, v194, vcc
    v_cndmask_b32 v195, v197, v196, vcc
    v_lshl_add_u32 v3, v61, 2, v62
    s_lshl_b32 s5, s10, 7
    v_add_u32 v3, s5, v3
    s_lshl_b32 s5, s9, 11
    s_add_u32 s5, s5, 6144
    v_lshl_add_u32 v198, v3, 2, s5
    s_mul_i32 s5, s9, 1152
    s_add_u32 s5, s5, 10304
    v_lshl_add_u32 v199, v3, 1, s5
    s_lshl_b32 s5, s44, 3
    s_add_u32 s5, s5, 10240
    v_lshl_add_u32 v202, v62, 2, s5
    s_lshl_b32 s5, s9, 5
    s_add_u32 s5, s5, 10240
    v_mov_b32 v203, s5
    s_cmp_eq_u32 s44, 0
    s_cbranch_scc0 L_f_nogbb
    s_cmp_lt_u32 s14, 32
    s_cbranch_scc0 L_f_nogbb
    s_lshr_b32 s5, s14, 4
    s_and_b32 s6, s14, 15
    s_lshr_b32 s3, s6, 1
    s_add_u32 s3, s3, 40
    s_lshl_b32 s3, s3, 11
    s_lshl_b32 s4, s5, 8
    s_add_u32 s3, s3, s4
    s_and_b32 s4, s6, 1
    s_lshl_b32 s4, s4, 7
    s_add_u32 s3, s3, s4
    s_add_u32 s75, s3, 4096
    v_and_b32 v3, 15, v0
    v_lshlrev_b32 v3, 1, v3
    v_add_u32 v3, v3, v62
    v_lshlrev_b32 v4, 2, v3
L_f_gbb:
    buffer_load_dword v218, v4, s[52:55], s75 offen offset:0 sc1
    buffer_load_dword v219, v4, s[52:55], s75 offen offset:512 sc1
    buffer_load_dword v220, v4, s[52:55], s75 offen offset:1024 sc1
    buffer_load_dword v221, v4, s[52:55], s75 offen offset:1536 sc1
    s_waitcnt vmcnt(0)
    v_bitop3_b32 v224, v218, v219, s45 bitop3:0x7e
    v_bitop3_b32 v225, v220, v221, s45 bitop3:0x7e
    v_or_b32 v224, v224, v225
    v_and_b32 v224, 0xff, v224
    v_cmp_ne_u32 vcc, 0, v224
    s_cbranch_vccz L_f_gbb_ok
    s_sub_u32 s47, s47, 1
    s_cmp_gt_i32 s47, 0
    s_cbranch_scc1 L_f_gbb
L_f_gbb_ok:
    v_and_b32 v218, 0xffffff00, v218
    v_and_b32 v219, 0xffffff00, v219
    v_and_b32 v220, 0xffffff00, v220
    v_and_b32 v221, 0xffffff00, v221
    v_add_f32 v218, v218, v219
    v_add_f32 v220, v220, v221
    v_add_f32 v204, v218, v220
    v_cvt_pk_bf16_f32 v224, v204, v204
    v_lshlrev_b32 v204, 16, v224
    v_mov_b32 v205, v3
L_f_nogbb:
    s_waitcnt vmcnt(0)
    v_perm_b32 v96, v68, v64, s64
    v_perm_b32 v100, v68, v64, s65
    v_perm_b32 v104, v69, v65, s64
    v_perm_b32 v108, v69, v65, s65
    v_perm_b32 v112, v70, v66, s64
    v_perm_b32 v116, v70, v66, s65
    v_perm_b32 v120, v71, v67, s64
    v_perm_b32 v124, v71, v67, s65
    v_perm_b32 v97, v76, v72, s64
    v_perm_b32 v101, v76, v72, s65
    v_perm_b32 v105, v77, v73, s64
    v_perm_b32 v109, v77, v73, s65
    v_perm_b32 v113, v78, v74, s64
    v_perm_b32 v117, v78, v74, s65
    v_perm_b32 v121, v79, v75, s64
    v_perm_b32 v125, v79, v75, s65
    v_perm_b32 v98, v84, v80, s64
    v_perm_b32 v102, v84, v80, s65
    v_perm_b32 v106, v85, v81, s64
    v_perm_b32 v110, v85, v81, s65
    v_perm_b32 v114, v86, v82, s64
    v_perm_b32 v118, v86, v82, s65
    v_perm_b32 v122, v87, v83, s64
    v_perm_b32 v126, v87, v83, s65
    v_perm_b32 v99, v92, v88, s64
    v_perm_b32 v103, v92, v88, s65
    v_perm_b32 v107, v93, v89, s64
    v_perm_b32 v111, v93, v89, s65
    v_perm_b32 v115, v94, v90, s64
    v_perm_b32 v119, v94, v90, s65
    v_perm_b32 v123, v95, v91, s64
    v_perm_b32 v127, v95, v91, s65
L_f_x:
    s_lshr_b32 s9, s44, 2
    s_and_b32 s10, s44, 3
    v_and_b32 v61, 31, v0
    v_lshrrev_b32 v62, 5, v0
    v_lshlrev_b32 v63, 11, v62
    v_lshl_add_u32 v63, v61, 4, v63
    s_lshl_b32 s5, s9, 14
    s_lshl_b32 s6, s10, 9
    s_add_u32 s5, s5, s6
    s_add_u32 s11, s5, 1048576
    s_add_u32 s12, s11, 4096
    s_add_u32 s13, s11, 8192
    s_add_u32 s79, s11, 12288
    v_mov_b32 v5, 0xffffff00
L_f_hx:
    buffer_load_dwordx4 v[224:227], v63, s[52:55], s11 offen sc1
    buffer_load_dwordx4 v[228:231], v63, s[52:55], s12 offen sc1
    buffer_load_dwordx4 v[232:235], v63, s[52:55], s13 offen sc1
    buffer_load_dwordx4 v[236:239], v63, s[52:55], s79 offen sc1
    s_waitcnt vmcnt(0)
    v_bitop3_b32 v240, v224, v225, s45 bitop3:0x7e
    v_bitop3_b32 v241, v226, v227, s45 bitop3:0x7e
    v_bitop3_b32 v242, v228, v229, s45 bitop3:0x7e
    v_bitop3_b32 v243, v230, v231, s45 bitop3:0x7e
    v_bitop3_b32 v244, v232, v233, s45 bitop3:0x7e
    v_bitop3_b32 v245, v234, v235, s45 bitop3:0x7e
    v_bitop3_b32 v246, v236, v237, s45 bitop3:0x7e
    v_bitop3_b32 v247, v238, v239, s45 bitop3:0x7e
    v_or3_b32 v240, v240, v241, v242
    v_or3_b32 v243, v243, v244, v245
    v_or_b32 v246, v246, v247
    v_or3_b32 v240, v240, v243, v246
    v_and_b32 v240, 0xff, v240
    v_cmp_ne_u32 vcc, 0, v240
    s_cbranch_vccz L_f_hx_ok
    s_sub_u32 s47, s47, 1
    s_cmp_gt_i32 s47, 0
    s_cbranch_scc1 L_f_hx
L_f_hx_ok:
    v_and_b32 v224, 0xffffff00, v224
    v_and_b32 v225, 0xffffff00, v225
    v_and_b32 v226, 0xffffff00, v226
    v_and_b32 v227, 0xffffff00, v227
    v_and_b32 v228, 0xffffff00, v228
    v_and_b32 v229, 0xffffff00, v229
    v_and_b32 v230, 0xffffff00, v230
    v_and_b32 v231, 0xffffff00, v231
    v_and_b32 v232, 0xffffff00, v232
    v_and_b32 v233, 0xffffff00, v233
    v_and_b32 v234, 0xffffff00, v234
    v_and_b32 v235, 0xffffff00, v235
    v_and_b32 v236, 0xffffff00, v236
    v_and_b32 v237, 0xffffff00, v237
    v_and_b32 v238, 0xffffff00, v238
    v_and_b32 v239, 0xffffff00, v239
    v_pk_add_f32 v[224:225], v[224:225], v[228:229]
    v_pk_add_f32 v[226:227], v[226:227], v[230:231]
    v_pk_add_f32 v[232:233], v[232:233], v[236:237]
    v_pk_add_f32 v[234:235], v[234:235], v[238:239]
    v_pk_add_f32 v[224:225], v[224:225], v[232:233]
    v_pk_add_f32 v[226:227], v[226:227], v[234:235]
    s_nop 0
    v_permlane32_swap_b32 v224, v225
    v_permlane32_swap_b32 v226, v227
    v_add_f32 v224, v224, v225
    v_add_f32 v225, v226, v227
    v_cvt_pk_bf16_f32 v228, v224, v225
    v_lshlrev_b32 v224, 16, v228
    v_and_b32 v225, 0xffff0000, v228
    v_mul_f32 v224, v192, v224
    v_mul_f32 v225, v193, v225
    v_cvt_pk_bf16_f32 v228, v224, v225
    v_lshlrev_b32 v224, 16, v228
    v_and_b32 v225, 0xffff0000, v228
    v_add_f32 v224, v194, v224
    v_add_f32 v225, v195, v225
    v_cvt_pk_bf16_f32 v228, v224, v225
    v_lshlrev_b32 v224, 16, v228
    v_and_b32 v225, 0xffff0000, v228
    v_add_f32 v228, v224, v225
    v_mul_f32 v229, v224, v224
    ds_write_b32 v198, v224
    v_fmac_f32 v229, v225, v225
    ds_write_b32 v198, v225 offset:8
    v_add_f32_dpp v228, v228, v228 row_ror:1 row_mask:0xf bank_mask:0xf
    v_add_f32_dpp v229, v229, v229 row_ror:1 row_mask:0xf bank_mask:0xf
    s_nop 0
    v_add_f32_dpp v228, v228, v228 row_ror:2 row_mask:0xf bank_mask:0xf
    v_add_f32_dpp v229, v229, v229 row_ror:2 row_mask:0xf bank_mask:0xf
    s_nop 0
    v_add_f32_dpp v228, v228, v228 row_ror:4 row_mask:0xf bank_mask:0xf
    v_add_f32_dpp v229, v229, v229 row_ror:4 row_mask:0xf bank_mask:0xf
    s_nop 0
    v_add_f32_dpp v228, v228, v228 row_ror:8 row_mask:0xf bank_mask:0xf
    v_add_f32_dpp v229, v229, v229 row_ror:8 row_mask:0xf bank_mask:0xf
    s_nop 1
    v_permlane32_swap_b32 v228, v229
    v_add_f32 v228, v228, v229
    v_mov_b32 v229, v228
    s_nop 1
    v_permlane16_swap_b32 v228, v229
    v_add_f32 v228, v228, v229
    ds_write_b32 v202, v228
    s_waitcnt lgkmcnt(0)
    s_barrier
    ds_read_b128 v[228:231], v203
    ds_read_b128 v[232:235], v203 offset:16
    s_waitcnt lgkmcnt(0)
    v_add_f32 v228, v228, v230
    v_add_f32 v229, v229, v231
    v_add_f32 v232, v232, v234
    v_add_f32 v233, v233, v235
    v_add_f32 v228, v228, v232
    v_add_f32 v229, v229, v233
    v_mul_f32 v228, 0x3b000000, v228
    v_mul_f32 v229, 0x3b000000, v229
    v_fma_f32 v229, -v228, v228, v229
    v_max_f32 v229, 0, v229
    v_cvt_pk_bf16_f32 v232, v228, v229
    v_lshlrev_b32 v228, 16, v232
    v_and_b32 v229, 0xffff0000, v232
    v_add_f32 v229, 0x3727c5ac, v229
    v_cvt_pk_bf16_f32 v232, v229, v229
    v_lshlrev_b32 v229, 16, v232
    v_sqrt_f32 v229, v229
    s_nop 0
    v_cvt_pk_bf16_f32 v232, v229, v229
    v_lshlrev_b32 v229, 16, v232
    v_rcp_f32 v229, v229
    v_sub_f32 v226, v224, v228
    v_sub_f32 v227, v225, v228
    v_cvt_pk_bf16_f32 v232, v226, v227
    v_lshlrev_b32 v226, 16, v232
    v_and_b32 v227, 0xffff0000, v232
    v_mul_f32 v226, v226, v229
    v_mul_f32 v227, v227, v229
    v_cvt_pk_bf16_f32 v232, v226, v227
    v_lshlrev_b32 v226, 16, v232
    v_and_b32 v227, 0xffff0000, v232
    v_mul_f32 v226, v226, v208
    v_mul_f32 v227, v227, v209
    v_cvt_pk_bf16_f32 v232, v226, v227
    v_lshlrev_b32 v226, 16, v232
    v_and_b32 v227, 0xffff0000, v232
    v_add_f32 v226, v226, v200
    v_add_f32 v227, v227, v201
    v_cvt_pk_bf16_f32 v226, v226, v227
    ds_write_b16 v199, v226
    ds_write_b16_d16_hi v199, v226 offset:4
    s_waitcnt lgkmcnt(0)
    s_barrier
    s_cmp_lt_u32 s44, 4
    s_cbranch_scc0 L_f_dwait
    ds_read_b128 v[16:19], v6
    ds_read_b128 v[20:23], v6 offset:256
    s_waitcnt lgkmcnt(0)
    v_mfma_f32_16x16x32_bf16 v[24:27], v[16:19], v[128:131], 0
    v_mfma_f32_16x16x32_bf16 v[28:31], v[16:19], v[132:135], 0
    v_mfma_f32_16x16x32_bf16 v[32:35], v[16:19], v[136:139], 0
    v_mfma_f32_16x16x32_bf16 v[36:39], v[16:19], v[140:143], 0
    v_mfma_f32_16x16x32_bf16 v[40:43], v[16:19], v[144:147], 0
    v_mfma_f32_16x16x32_bf16 v[44:47], v[16:19], v[148:151], 0
    v_mfma_f32_16x16x32_bf16 v[48:51], v[16:19], v[152:155], 0
    v_mfma_f32_16x16x32_bf16 v[52:55], v[16:19], v[156:159], 0
    v_mfma_f32_16x16x32_bf16 v[24:27], v[20:23], v[160:163], v[24:27]
    v_mfma_f32_16x16x32_bf16 v[28:31], v[20:23], v[164:167], v[28:31]
    v_mfma_f32_16x16x32_bf16 v[32:35], v[20:23], v[168:171], v[32:35]
    v_mfma_f32_16x16x32_bf16 v[36:39], v[20:23], v[172:175], v[36:39]
    v_mfma_f32_16x16x32_bf16 v[40:43], v[20:23], v[176:179], v[40:43]
    v_mfma_f32_16x16x32_bf16 v[44:47], v[20:23], v[180:183], v[44:47]
    v_mfma_f32_16x16x32_bf16 v[48:51], v[20:23], v[184:187], v[48:51]
    v_mfma_f32_16x16x32_bf16 v[52:55], v[20:23], v[188:191], v[52:55]
    s_nop 0
    v_add_f32_dpp v8, v25, v24 row_ror:12 row_mask:0xf bank_mask:0x1
    v_add_f32_dpp v9, v28, v29 row_ror:4 row_mask:0xf bank_mask:0x2
    v_add_f32_dpp v10, v32, v34 row_ror:8 row_mask:0xf bank_mask:0x4
    v_add_f32_dpp v11, v36, v39 row_ror:12 row_mask:0xf bank_mask:0x8
    v_add_f32_dpp v12, v41, v40 row_ror:12 row_mask:0xf bank_mask:0x1
    v_add_f32_dpp v13, v44, v45 row_ror:4 row_mask:0xf bank_mask:0x2
    v_add_f32_dpp v14, v48, v50 row_ror:8 row_mask:0xf bank_mask:0x4
    v_add_f32_dpp v15, v52, v55 row_ror:12 row_mask:0xf bank_mask:0x8
    v_add_f32_dpp v8, v26, v8 row_ror:8 row_mask:0xf bank_mask:0x1
    v_add_f32_dpp v9, v30, v9 row_ror:12 row_mask:0xf bank_mask:0x2
    v_add_f32_dpp v10, v33, v10 row_ror:4 row_mask:0xf bank_mask:0x4
    v_add_f32_dpp v11, v37, v11 row_ror:8 row_mask:0xf bank_mask:0x8
    v_add_f32_dpp v12, v42, v12 row_ror:8 row_mask:0xf bank_mask:0x1
    v_add_f32_dpp v13, v46, v13 row_ror:12 row_mask:0xf bank_mask:0x2
    v_add_f32_dpp v14, v49, v14 row_ror:4 row_mask:0xf bank_mask:0x4
    v_add_f32_dpp v15, v53, v15 row_ror:8 row_mask:0xf bank_mask:0x8
    v_add_f32_dpp v56, v27, v8 row_ror:4 row_mask:0xf bank_mask:0x1
    v_add_f32_dpp v56, v31, v9 row_ror:8 row_mask:0xf bank_mask:0x2
    v_add_f32_dpp v56, v35, v10 row_ror:12 row_mask:0xf bank_mask:0x4
    v_add_f32_dpp v56, v38, v11 row_ror:4 row_mask:0xf bank_mask:0x8
    v_add_f32_dpp v57, v43, v12 row_ror:4 row_mask:0xf bank_mask:0x1
    v_add_f32_dpp v57, v47, v13 row_ror:8 row_mask:0xf bank_mask:0x2
    v_add_f32_dpp v57, v51, v14 row_ror:12 row_mask:0xf bank_mask:0x4
    v_add_f32_dpp v57, v54, v15 row_ror:4 row_mask:0xf bank_mask:0x8
    ds_write_b64 v7, v[56:57]
    s_waitcnt lgkmcnt(0)
    s_barrier
    s_cmp_eq_u32 s44, 1
    s_cbranch_scc0 L_f_noep
    s_cmp_eq_u32 s14, 31
    s_cbranch_scc0 L_f_noep
    s_add_u32 s5, s46, 1
    v_mov_b32 v28, s5
    v_cmp_eq_u32 vcc, 0, v0
    v_mov_b32 v29, 0
    v_mov_b32 v30, 1073741824
    v_cndmask_b32 v29, v30, v29, vcc
    buffer_store_dword v28, v29, s[52:55], 0 offen sc1
L_f_noep:
    s_cmp_eq_u32 s44, 0
    s_cbranch_scc0 L_f_end
    s_cmp_lt_u32 s14, 32
    s_cbranch_scc0 L_f_end
    s_mov_b32 s60, s38
    s_mov_b32 s61, s39
    s_mov_b32 s62, 2048
    s_mov_b32 s63, 0x00020000
    s_mul_i32 s5, s14, 7168
    s_add_u32 s11, s5, 2359296
    s_add_u32 s12, s11, 4096
    v_lshrrev_b32 v3, 4, v0
    v_lshlrev_b32 v3, 7, v3
    v_and_b32 v4, 15, v0
    v_lshl_add_u32 v8, v4, 3, v3
    s_lshr_b32 s5, s14, 4
    s_and_b32 s6, s14, 15
    s_lshl_b32 s3, s5, 9
    s_lshl_b32 s4, s6, 5
    s_add_u32 s3, s3, s4
    v_add_u32 v9, s3, v205
    v_lshlrev_b32 v10, 2, v9
    v_add_u32 v10, 6144, v10
    ds_read_b32 v11, v10
    v_lshlrev_b32 v9, 1, v9
    v_bfe_u32 v3, v0, 4, 1
    v_cmp_eq_u32 vcc, 0, v3
    v_mov_b32 v4, 1073741824
    s_nop 0
    v_cndmask_b32 v9, v4, v9, vcc
    s_barrier
L_f_h6:
    buffer_load_dwordx2 v[24:25], v8, s[52:55], s11 offen offset:0 sc1
    buffer_load_dwordx2 v[26:27], v8, s[52:55], s11 offen offset:512 sc1
    buffer_load_dwordx2 v[28:29], v8, s[52:55], s11 offen offset:1024 sc1
    buffer_load_dwordx2 v[30:31], v8, s[52:55], s11 offen offset:1536 sc1
    buffer_load_dwordx2 v[32:33], v8, s[52:55], s11 offen offset:2048 sc1
    buffer_load_dwordx2 v[34:35], v8, s[52:55], s11 offen offset:2560 sc1
    buffer_load_dwordx2 v[36:37], v8, s[52:55], s11 offen offset:3072 sc1
    buffer_load_dwordx2 v[38:39], v8, s[52:55], s11 offen offset:3584 sc1
    buffer_load_dwordx2 v[40:41], v8, s[52:55], s12 offen offset:0 sc1
    buffer_load_dwordx2 v[42:43], v8, s[52:55], s12 offen offset:512 sc1
    buffer_load_dwordx2 v[44:45], v8, s[52:55], s12 offen offset:1024 sc1
    buffer_load_dwordx2 v[46:47], v8, s[52:55], s12 offen offset:1536 sc1
    buffer_load_dwordx2 v[48:49], v8, s[52:55], s12 offen offset:2048 sc1
    buffer_load_dwordx2 v[50:51], v8, s[52:55], s12 offen offset:2560 sc1
    s_waitcnt vmcnt(0)
    v_bitop3_b32 v64, v24, v25, s45 bitop3:0x7e
    v_bitop3_b32 v65, v26, v27, s45 bitop3:0x7e
    v_bitop3_b32 v66, v28, v29, s45 bitop3:0x7e
    v_bitop3_b32 v67, v30, v31, s45 bitop3:0x7e
    v_bitop3_b32 v68, v32, v33, s45 bitop3:0x7e
    v_bitop3_b32 v69, v34, v35, s45 bitop3:0x7e
    v_bitop3_b32 v70, v36, v37, s45 bitop3:0x7e
    v_bitop3_b32 v71, v38, v39, s45 bitop3:0x7e
    v_bitop3_b32 v72, v40, v41, s45 bitop3:0x7e
    v_bitop3_b32 v73, v42, v43, s45 bitop3:0x7e
    v_bitop3_b32 v74, v44, v45, s45 bitop3:0x7e
    v_bitop3_b32 v75, v46, v47, s45 bitop3:0x7e
    v_bitop3_b32 v76, v48, v49, s45 bitop3:0x7e
    v_bitop3_b32 v77, v50, v51, s45 bitop3:0x7e
    v_or3_b32 v64, v64, v65, v66
    v_or3_b32 v67, v67, v68, v69
    v_or3_b32 v70, v70, v71, v72
    v_or3_b32 v73, v73, v74, v75
    v_or_b32 v76, v76, v77
    v_or3_b32 v64, v64, v67, v70
    v_or_b32 v73, v73, v76
    v_or_b32 v64, v64, v73
    v_and_b32 v64, 0xff, v64
    v_cmp_ne_u32 vcc, 0, v64
    s_cbranch_vccz L_f_h6_ok
    s_sub_u32 s47, s47, 1
    s_cmp_gt_i32 s47, 0
    s_cbranch_scc1 L_f_h6
L_f_h6_ok:
    v_and_b32 v24, 0xffffff00, v24
    v_and_b32 v25, 0xffffff00, v25
    v_and_b32 v26, 0xffffff00, v26
    v_and_b32 v27, 0xffffff00, v27
    v_and_b32 v28, 0xffffff00, v28
    v_and_b32 v29, 0xffffff00, v29
    v_and_b32 v30, 0xffffff00, v30
    v_and_b32 v31, 0xffffff00, v31
    v_and_b32 v32, 0xffffff00, v32
    v_and_b32 v33, 0xffffff00, v33
    v_and_b32 v34, 0xffffff00, v34
    v_and_b32 v35, 0xffffff00, v35
    v_and_b32 v36, 0xffffff00, v36
    v_and_b32 v37, 0xffffff00, v37
    v_and_b32 v38, 0xffffff00, v38
    v_and_b32 v39, 0xffffff00, v39
    v_and_b32 v40, 0xffffff00, v40
    v_and_b32 v41, 0xffffff00, v41
    v_and_b32 v42, 0xffffff00, v42
    v_and_b32 v43, 0xffffff00, v43
    v_and_b32 v44, 0xffffff00, v44
    v_and_b32 v45, 0xffffff00, v45
    v_and_b32 v46, 0xffffff00, v46
    v_and_b32 v47, 0xffffff00, v47
    v_and_b32 v48, 0xffffff00, v48
    v_and_b32 v49, 0xffffff00, v49
    v_and_b32 v50, 0xffffff00, v50
    v_and_b32 v51, 0xffffff00, v51
    v_pk_add_f32 v[24:25], v[24:25], v[38:39]
    v_pk_add_f32 v[26:27], v[26:27], v[40:41]
    v_pk_add_f32 v[28:29], v[28:29], v[42:43]
    v_pk_add_f32 v[30:31], v[30:31], v[44:45]
    v_pk_add_f32 v[32:33], v[32:33], v[46:47]
    v_pk_add_f32 v[34:35], v[34:35], v[48:49]
    v_pk_add_f32 v[36:37], v[36:37], v[50:51]
    v_pk_add_f32 v[24:25], v[24:25], v[26:27]
    v_pk_add_f32 v[28:29], v[28:29], v[30:31]
    v_pk_add_f32 v[32:33], v[32:33], v[34:35]
    v_pk_add_f32 v[24:25], v[24:25], v[28:29]
    v_pk_add_f32 v[32:33], v[32:33], v[36:37]
    v_pk_add_f32 v[24:25], v[24:25], v[32:33]
    s_nop 1
    v_permlane32_swap_b32 v24, v25
    v_add_f32 v24, v24, v25
    v_mov_b32 v25, v24
    s_nop 1
    v_permlane16_swap_b32 v24, v25
    v_add_f32 v24, v24, v25
    v_cvt_pk_bf16_f32 v64, v24, v24
    v_lshlrev_b32 v24, 16, v64
    v_mul_f32 v24, v204, v24
    v_cvt_pk_bf16_f32 v64, v24, v24
    v_lshlrev_b32 v24, 16, v64
    s_waitcnt lgkmcnt(0)
    v_add_f32 v24, v11, v24
    v_cvt_pk_bf16_f32 v24, v24, v24
    buffer_store_short v24, v9, s[60:63], 0 offen
L_f_end:
    s_endpgm
L_f_dwait:
    s_barrier
    ds_read_b32 v24, v7
    ds_read_b32 v25, v7 offset:256
    ds_read_b32 v26, v7 offset:512
    ds_read_b32 v27, v7 offset:768
    s_mov_b32 s3, 0x3d372713
    s_mov_b32 s4, 0xc0135761
    s_waitcnt lgkmcnt(0)
    v_add_f32 v24, v24, v25
    v_add_f32 v26, v26, v27
    v_cvt_pk_bf16_f32 v28, v24, v26
    v_lshlrev_b32 v24, 16, v28
    v_and_b32 v26, 0xffff0000, v28
    v_mul_f32 v25, v24, v24
    v_fma_f32 v25, v25, s3, 1.0
    v_mul_f32 v25, v25, v24
    v_mul_f32 v25, s4, v25
    v_exp_f32 v25, v25
    s_nop 0
    v_add_f32 v25, 1.0, v25
    v_rcp_f32 v25, v25
    s_nop 0
    v_mul_f32 v24, v24, v25
    v_cvt_pk_bf16_f32 v28, v24, v24
    v_lshlrev_b32 v24, 16, v28
    v_mul_f32 v24, v24, v26
    v_cvt_pk_bf16_f32 v24, v24, v24
    ds_write_b16 v60, v24
    s_waitcnt lgkmcnt(0)
    ds_read_b128 v[16:19], v6
    s_waitcnt lgkmcnt(0)
    v_mfma_f32_16x16x32_bf16 v[24:27], v[16:19], v[96:99], 0
    v_mfma_f32_16x16x32_bf16 v[28:31], v[16:19], v[100:103], 0
    v_mfma_f32_16x16x32_bf16 v[32:35], v[16:19], v[104:107], 0
    v_mfma_f32_16x16x32_bf16 v[36:39], v[16:19], v[108:111], 0
    v_mfma_f32_16x16x32_bf16 v[40:43], v[16:19], v[112:115], 0
    v_mfma_f32_16x16x32_bf16 v[44:47], v[16:19], v[116:119], 0
    v_mfma_f32_16x16x32_bf16 v[48:51], v[16:19], v[120:123], 0
    v_mfma_f32_16x16x32_bf16 v[52:55], v[16:19], v[124:127], 0
    s_nop 0
    v_mov_b32_dpp v56, v24 quad_perm:[0,1,2,3] row_mask:0x1 bank_mask:0xf
    v_mov_b32_dpp v57, v28 quad_perm:[0,1,2,3] row_mask:0x1 bank_mask:0xf
    v_mov_b32_dpp v58, v32 quad_perm:[0,1,2,3] row_mask:0x1 bank_mask:0xf
    v_mov_b32_dpp v59, v36 quad_perm:[0,1,2,3] row_mask:0x1 bank_mask:0xf
    v_mov_b32_dpp v56, v40 quad_perm:[0,1,2,3] row_mask:0x2 bank_mask:0xf
    v_mov_b32_dpp v57, v44 quad_perm:[0,1,2,3] row_mask:0x2 bank_mask:0xf
    v_mov_b32_dpp v58, v48 quad_perm:[0,1,2,3] row_mask:0x2 bank_mask:0xf
    v_mov_b32_dpp v59, v52 quad_perm:[0,1,2,3] row_mask:0x2 bank_mask:0xf
    v_mov_b32_dpp v56, v25 quad_perm:[0,1,2,3] row_mask:0x4 bank_mask:0xf
    v_mov_b32_dpp v57, v29 quad_perm:[0,1,2,3] row_mask:0x4 bank_mask:0xf
    v_mov_b32_dpp v58, v33 quad_perm:[0,1,2,3] row_mask:0x4 bank_mask:0xf
    v_mov_b32_dpp v59, v37 quad_perm:[0,1,2,3] row_mask:0x4 bank_mask:0xf
    v_mov_b32_dpp v56, v41 quad_perm:[0,1,2,3] row_mask:0x8 bank_mask:0xf
    v_mov_b32_dpp v57, v45 quad_perm:[0,1,2,3] row_mask:0x8 bank_mask:0xf
    v_mov_b32_dpp v58, v49 quad_perm:[0,1,2,3] row_mask:0x8 bank_mask:0xf
    v_mov_b32_dpp v59, v53 quad_perm:[0,1,2,3] row_mask:0x8 bank_mask:0xf
    v_bfi_b32 v56, v5, v56, s45
    v_bfi_b32 v57, v5, v57, s45
    v_bfi_b32 v58, v5, v58, s45
    v_bfi_b32 v59, v5, v59, s45
    buffer_store_dwordx4 v[56:59], v1, s[52:55], s77 offen sc1
    s_waitcnt vmcnt(0)
    s_barrier
L_end:
    s_endpgm
L_code_end:
.section .rodata,"a"
.p2align 6
.amdhsa_kernel adaLN_cond__sliding_block_cached__geglu_ffn__decode_kernel
  .amdhsa_next_free_vgpr 256
  .amdhsa_next_free_sgpr 102
  .amdhsa_accum_offset 256
  .amdhsa_group_segment_fixed_size 0
  .amdhsa_kernarg_size 112
  .amdhsa_user_sgpr_count 2
  .amdhsa_user_sgpr_kernarg_segment_ptr 1
  .amdhsa_system_sgpr_workgroup_id_x 1
.end_amdhsa_kernel
```
